```python
import torch

def _softmax(x, axis=-1):
    return torch.softmax(x, dim=axis)
def _gelu(x):
    return torch.nn.functional.gelu(x, approximate="tanh")
def _silu(x):
    return torch.nn.functional.silu(x)
def _sigmoid(x):
    return torch.sigmoid(x)
def _layernorm(x, axis=-1, eps=1e-5):
    m = x.mean(dim=axis, keepdim=True)
    v = x.var(dim=axis, keepdim=True, unbiased=False)
    return (x - m) / torch.sqrt(v + eps)
def _scatter_add(tgt, idx, src, axis=0):
    return tgt.clone().index_add_(axis, idx, src)
def _segment_sum(src, seg, n):
    out = torch.zeros((n,) + src.shape[1:], dtype=src.dtype)
    return out.index_add_(0, seg, src)
def _pad(x, pw):
    flat = tuple(v for pair in reversed(pw) for v in pair)
    return torch.nn.functional.pad(x, flat)

kernel_name = 'concat_heads__linear_kernel_hedgehog__softmax_full_mha__prompt'

def setup_inputs():

    _w = (lambda a: (lambda t: t.to(torch.bfloat16) if t.is_floating_point() else t)(torch.as_tensor(a)))
    def _A_setup():
        B, S, D, H = 1, 2048, 576, 32
        Dh = D // H
        return {
            "x": _w((lambda *s: torch.randn(*s, dtype=torch.bfloat16) * 0.4)(B, S, D)),
            "wqkv": _w((lambda *s: torch.randn(*s, dtype=torch.bfloat16) * 0.4)(D, 3 * D)),
            "w_phi": _w((lambda *s: torch.randn(*s, dtype=torch.bfloat16) * 0.4)(H, Dh, Dh) * (Dh ** -0.5)),
            "wo": _w((lambda *s: torch.randn(*s, dtype=torch.bfloat16) * 0.05)(D, D)),
        }
    _A_in = _A_setup()

    def _B_setup():
        B, S, D = 1, 2048, 576
        return {
            "x": _w((lambda *s: torch.randn(*s, dtype=torch.bfloat16) * 0.2)(B, S, D)),
            "wqkv": _w((lambda *s: torch.randn(*s, dtype=torch.bfloat16) * 0.2)(D, 3 * D)),
            "wo": _w((lambda *s: torch.randn(*s, dtype=torch.bfloat16) * 0.05)(D, D)),
        }
    _B_in = _B_setup()

    return {
        "A_x": _A_in["x"],
        "A_wqkv": _A_in["wqkv"],
        "A_w_phi": _A_in["w_phi"],
        "A_wo": _A_in["wo"],
        "B_x": _B_in["x"],
        "B_wqkv": _B_in["wqkv"],
        "B_wo": _B_in["wo"],
    }

def reference(A_x, A_wqkv, A_w_phi, A_wo, B_x, B_wqkv, B_wo):
    def _A_ref(x, wqkv, w_phi, wo):
        B, S, D = x.shape
        H = 32; Dh = D // H
        qkv = (lambda x, *d: x.permute(*d))((x @ wqkv).reshape(B, S, 3, H, Dh), 2, 0, 3, 1, 4)
        q, k, v = qkv[0], qkv[1], qkv[2]
        pq = torch.einsum("bhsd,hdf->bhsf", q, w_phi)
        pk = torch.einsum("bhsd,hdf->bhsf", k, w_phi)
        phi_q = torch.concatenate([_softmax(pq, axis=-1), _softmax(-pq, axis=-1)], axis=-1)
        phi_k = torch.concatenate([_softmax(pk, axis=-1), _softmax(-pk, axis=-1)], axis=-1)
        kv = torch.einsum("bhsf,bhsd->bhfd", phi_k, v)
        z  = torch.einsum("bhsf->bhf", phi_k)
        num = torch.einsum("bhqf,bhfd->bhqd", phi_q, kv)
        den = torch.einsum("bhqf,bhf->bhq", phi_q, z)[..., None] + 1e-6
        o = num / den
        return (lambda x, *d: x.permute(*d))(o, 0, 2, 1, 3).reshape(B, S, D) @ wo

    def _B_ref(x, wqkv, wo):
        B, S, D = x.shape
        H = 32; Dh = D // H
        qkv = (lambda x, *d: x.permute(*d))((x @ wqkv).reshape(B, S, 3, H, Dh), 2, 0, 3, 1, 4)
        q, k, v = qkv[0], qkv[1], qkv[2]
        scale = Dh ** -0.5
        scores = torch.einsum("bhqd,bhkd->bhqk", q, k) * scale
        p = _softmax(scores, axis=-1)
        o = torch.einsum("bhqk,bhkd->bhqd", p, v)
        return (lambda x, *d: x.permute(*d))(o, 0, 2, 1, 3).reshape(B, S, D) @ wo

    a = _A_ref(A_x, A_wqkv, A_w_phi, A_wo)
    b = _B_ref(B_x, B_wqkv, B_wo)
    return torch.concatenate([a, b], axis=-1)
```

```asm
; @launch grid=(256,1,1) block=(768,1,1) lds=163840
.amdgcn_target "amdgcn-amd-amdhsa--gfx950"
.text
.globl concat_heads__linear_kernel_hedgehog__softmax_full_mha__prompt_kernel
.p2align 8
.type concat_heads__linear_kernel_hedgehog__softmax_full_mha__prompt_kernel,@function
concat_heads__linear_kernel_hedgehog__softmax_full_mha__prompt_kernel:
  s_cmp_ge_u32 s2, 256
  s_cbranch_scc1 concat_heads__linear_kernel_hedgehog__softmax_full_mha__prompt_kernel_end
  s_load_dwordx16 s[36:51], s[0:1], 0
  s_load_dwordx4 s[52:55], s[0:1], 64
  v_lshrrev_b32 v1, 6, v0
  v_and_b32 v0, 63, v0
  s_lshr_b32 s3, s2, 3
  v_readfirstlane_b32 s24, v1
  s_and_b32 s56, s3, 3
  s_and_b32 s30, s2, 3
  s_lshl_b32 s30, s30, 2
  s_or_b32 s30, s30, s56
  s_lshr_b32 s33, s3, 2
  s_bfe_u32 s31, s2, 65538
  s_mul_i32 s31, s31, 7
  s_add_u32 s31, s31, s33
  s_cmp_eq_u32 s33, 7
  s_cselect_b32 s31, 15, s31
  s_and_b32 s32, s2, 7
  s_lshl_b32 s32, s32, 2
  s_or_b32 s32, s32, s56
  v_lshlrev_b32 v1, 4, v0
  v_lshrrev_b32 v8, 5, v0
  v_and_b32 v9, 31, v0
  s_cmp_ge_u32 s24, 4
  s_cbranch_scc0 concat_heads__linear_kernel_hedgehog__softmax_full_mha__prompt_kernel_gc
  s_cmp_ge_u32 s24, 8
  s_cbranch_scc1 concat_heads__linear_kernel_hedgehog__softmax_full_mha__prompt_kernel_pre
  s_sub_u32 s68, s24, 4
  v_lshrrev_b32 v2, 3, v0
  v_mul_u32_u24 v2, 1152, v2
  v_lshrrev_b32 v3, 4, v0
  v_and_b32 v4, 7, v0
  v_xor_b32 v4, v4, v3
  v_lshl_add_u32 v10, v4, 4, v2
  v_xor_b32 v4, 4, v4
  v_lshl_add_u32 v11, v4, 4, v2
  v_add_u32 v11, 9216, v11
  s_mul_i32 s56, s30, 147456
  s_mul_i32 s57, s68, 36864
  s_add_u32 s64, s56, s57
  s_mov_b32 s69, s64
  s_lshl_b32 s27, s68, 12
  s_mov_b32 s34, 95232
  s_add_u32 s35, s27, 16384
  s_lshl_b32 s65, s31, 8
  s_mul_i32 s57, s68, 55296
  s_add_u32 s65, s65, s57
  s_mov_b32 s3, s65
  v_lshrrev_b32 v2, 4, v0
  v_lshlrev_b32 v3, 2, v2
  v_and_b32 v4, 15, v0
  v_xor_b32 v4, v4, v3
  v_mul_u32_u24 v2, 3456, v2
  v_lshl_add_u32 v12, v4, 4, v2
  s_cmp_eq_u32 s31, 13
  s_cselect_b32 s56, 8, 16
  v_cmp_gt_u32 vcc, s56, v4
  v_mov_b32 v18, 0x7fff0000
  s_nop 0
  v_cndmask_b32 v12, v18, v12, vcc
  s_bfe_u32 s56, s2, 131075
  s_lshl_b32 s56, s56, 1
  s_add_u32 s66, s56, s33
  s_and_b32 s56, s2, 7
  s_add_u32 s66, s66, s56
  s_mul_i32 s56, s66, 57
  s_lshr_b32 s56, s56, 9
  s_mul_i32 s56, s56, 9
  s_sub_u32 s66, s66, s56
  s_lshl_b32 s56, s66, 7
  s_add_u32 s64, s64, s56
  s_mul_i32 s56, s66, 221184
  s_add_u32 s65, s65, s56
  s_mov_b32 s69, s64
  s_mov_b32 s3, s65
  s_mov_b32 s67, s66
  s_barrier
  s_waitcnt lgkmcnt(0)
  s_cmp_eq_u32 s31, 15
  s_cbranch_scc0 concat_heads__linear_kernel_hedgehog__softmax_full_mha__prompt_kernel_lact
  s_and_b32 s57, s2, 31
  s_lshl_b32 s57, s57, 2
  s_add_u32 s57, s57, s24
  s_sub_u32 s57, s57, 4
  v_lshlrev_b32 v2, 7, v0
  s_waitcnt vmcnt(0)
  s_branch concat_heads__linear_kernel_hedgehog__softmax_full_mha__prompt_kernel_ldone
concat_heads__linear_kernel_hedgehog__softmax_full_mha__prompt_kernel_lact:
  s_mov_b32 s8, s44
  s_mov_b32 s9, s45
  s_mov_b32 s10, 2359296
  s_mov_b32 s11, 0x20000
  s_mov_b32 s12, s46
  s_mov_b32 s13, s47
  s_mov_b32 s14, 1990656
  s_mov_b32 s15, 0x20000
  s_lshl_b32 s96, s68, 2
  s_add_u32 s96, s96, 161120
  s_add_u32 s56, s34, s27
  s_mov_b32 m0, s56
  s_add_u32 s57, s69, 18432
  buffer_load_dwordx4 v10, s[8:11], s69 offen lds
  s_add_u32 m0, s56, 1024
  s_add_u32 s58, s34, s35
  buffer_load_dwordx4 v11, s[8:11], s69 offen lds
  s_add_u32 m0, s56, 2048
  s_add_u32 s69, s69, 128
  buffer_load_dwordx4 v10, s[8:11], s57 offen lds
  s_add_u32 m0, s56, 3072
  s_add_u32 s34, s34, 32768
  buffer_load_dwordx4 v11, s[8:11], s57 offen lds
  s_mov_b32 m0, s58
  s_cmp_eq_u32 s34, 160768
  s_cselect_b32 s34, 29696, s34
  buffer_load_dwordx4 v12, s[12:15], s3 offen lds
  s_add_u32 m0, s58, 1024
  s_add_u32 s59, s3, 13824
  buffer_load_dwordx4 v12, s[12:15], s59 offen lds
  s_add_u32 m0, s58, 2048
  s_add_u32 s59, s3, 27648
  buffer_load_dwordx4 v12, s[12:15], s59 offen lds
  s_add_u32 m0, s58, 3072
  s_add_u32 s59, s3, 41472
  buffer_load_dwordx4 v12, s[12:15], s59 offen lds
  s_add_u32 s3, s3, 221184
  s_add_u32 s67, s67, 1
  s_cmp_eq_u32 s67, 9
  s_cselect_b32 s56, 1152, 0
  s_cselect_b32 s57, 1990656, 0
  s_sub_u32 s69, s69, s56
  s_sub_u32 s3, s3, s57
  s_mov_b32 m0, s96
  s_mov_b64 exec, 1
  buffer_load_dword v18, s[12:15], 0 offen lds
  s_mov_b64 exec, -1
  s_add_u32 s96, s96, 16
  v_and_b32 v17, 3, v0
  v_lshlrev_b32 v17, 2, v17
  v_add_u32 v17, 160784, v17
  v_mov_b32 v16, 0
  s_mov_b32 s62, 1
  s_mov_b32 s61, 1048576
concat_heads__linear_kernel_hedgehog__softmax_full_mha__prompt_kernel_llb:
  s_waitcnt lgkmcnt(0)
  v_cmp_ne_u32 vcc, 0, v16
  s_cbranch_vccz concat_heads__linear_kernel_hedgehog__softmax_full_mha__prompt_kernel_lkb
  s_sub_u32 s61, s61, 1
  s_cbranch_scc1 concat_heads__linear_kernel_hedgehog__softmax_full_mha__prompt_kernel_lkb
  ds_read_b32 v16, v17
  s_branch concat_heads__linear_kernel_hedgehog__softmax_full_mha__prompt_kernel_llb
concat_heads__linear_kernel_hedgehog__softmax_full_mha__prompt_kernel_lkb:
  s_add_u32 s56, s34, s27
  s_mov_b32 m0, s56
  s_add_u32 s57, s69, 18432
  buffer_load_dwordx4 v10, s[8:11], s69 offen lds
  s_add_u32 m0, s56, 1024
  s_add_u32 s58, s34, s35
  buffer_load_dwordx4 v11, s[8:11], s69 offen lds
  s_add_u32 m0, s56, 2048
  s_add_u32 s69, s69, 128
  buffer_load_dwordx4 v10, s[8:11], s57 offen lds
  s_add_u32 m0, s56, 3072
  s_add_u32 s34, s34, 32768
  buffer_load_dwordx4 v11, s[8:11], s57 offen lds
  s_mov_b32 m0, s58
  s_cmp_eq_u32 s34, 160768
  s_cselect_b32 s34, 29696, s34
  buffer_load_dwordx4 v12, s[12:15], s3 offen lds
  s_add_u32 m0, s58, 1024
  s_add_u32 s59, s3, 13824
  buffer_load_dwordx4 v12, s[12:15], s59 offen lds
  v_add_u32 v17, 16, v17
  ds_read_b32 v16, v17
  s_add_u32 m0, s58, 2048
  s_add_u32 s59, s3, 27648
  buffer_load_dwordx4 v12, s[12:15], s59 offen lds
  s_add_u32 m0, s58, 3072
  s_add_u32 s59, s3, 41472
  buffer_load_dwordx4 v12, s[12:15], s59 offen lds
  s_add_u32 s3, s3, 221184
  s_add_u32 s67, s67, 1
  s_cmp_eq_u32 s67, 9
  s_cselect_b32 s56, 1152, 0
  s_cselect_b32 s57, 1990656, 0
  s_sub_u32 s69, s69, s56
  s_sub_u32 s3, s3, s57
  s_mov_b32 m0, s96
  s_mov_b64 exec, 1
  buffer_load_dword v18, s[12:15], 0 offen lds
  s_mov_b64 exec, -1
  s_add_u32 s96, s96, 16
  s_add_u32 s62, s62, 1
  s_cmp_lg_u32 s62, 9
  s_cbranch_scc1 concat_heads__linear_kernel_hedgehog__softmax_full_mha__prompt_kernel_llb
  s_mov_b32 s8, s36
  s_mov_b32 s9, s37
  s_mov_b32 s10, 2359296
  s_mov_b32 s11, 0x20000
  s_mov_b32 s12, s38
  s_mov_b32 s13, s39
  s_mov_b32 s14, 1990656
  s_mov_b32 s15, 0x20000
  s_mov_b32 s69, s64
  s_mov_b32 s3, s65
  s_mov_b32 s67, s66
concat_heads__linear_kernel_hedgehog__softmax_full_mha__prompt_kernel_lla:
  s_waitcnt lgkmcnt(0)
  v_cmp_ne_u32 vcc, 0, v16
  s_cbranch_vccz concat_heads__linear_kernel_hedgehog__softmax_full_mha__prompt_kernel_lka
  s_sub_u32 s61, s61, 1
  s_cbranch_scc1 concat_heads__linear_kernel_hedgehog__softmax_full_mha__prompt_kernel_lka
  ds_read_b32 v16, v17
  s_branch concat_heads__linear_kernel_hedgehog__softmax_full_mha__prompt_kernel_lla
concat_heads__linear_kernel_hedgehog__softmax_full_mha__prompt_kernel_lka:
  s_add_u32 s56, s34, s27
  s_mov_b32 m0, s56
  s_add_u32 s57, s69, 18432
  buffer_load_dwordx4 v10, s[8:11], s69 offen lds
  s_add_u32 m0, s56, 1024
  s_add_u32 s58, s34, s35
  buffer_load_dwordx4 v11, s[8:11], s69 offen lds
  s_add_u32 m0, s56, 2048
  s_add_u32 s69, s69, 128
  buffer_load_dwordx4 v10, s[8:11], s57 offen lds
  s_add_u32 m0, s56, 3072
  s_add_u32 s34, s34, 32768
  buffer_load_dwordx4 v11, s[8:11], s57 offen lds
  s_mov_b32 m0, s58
  s_cmp_eq_u32 s34, 160768
  s_cselect_b32 s34, 29696, s34
  buffer_load_dwordx4 v12, s[12:15], s3 offen lds
  s_add_u32 m0, s58, 1024
  s_add_u32 s59, s3, 13824
  buffer_load_dwordx4 v12, s[12:15], s59 offen lds
  v_add_u32 v17, 16, v17
  ds_read_b32 v16, v17
  s_add_u32 m0, s58, 2048
  s_add_u32 s59, s3, 27648
  buffer_load_dwordx4 v12, s[12:15], s59 offen lds
  s_add_u32 m0, s58, 3072
  s_add_u32 s59, s3, 41472
  buffer_load_dwordx4 v12, s[12:15], s59 offen lds
  s_add_u32 s3, s3, 221184
  s_add_u32 s67, s67, 1
  s_cmp_eq_u32 s67, 9
  s_cselect_b32 s56, 1152, 0
  s_cselect_b32 s57, 1990656, 0
  s_sub_u32 s69, s69, s56
  s_sub_u32 s3, s3, s57
  s_mov_b32 m0, s96
  s_mov_b64 exec, 1
  buffer_load_dword v18, s[12:15], 0 offen lds
  s_mov_b64 exec, -1
  s_add_u32 s96, s96, 16
  s_add_u32 s62, s62, 1
  s_cmp_lg_u32 s62, 18
  s_cbranch_scc1 concat_heads__linear_kernel_hedgehog__softmax_full_mha__prompt_kernel_lla
concat_heads__linear_kernel_hedgehog__softmax_full_mha__prompt_kernel_ldone:
  s_mov_b32 s4, s54
  s_mov_b32 s5, s55
  s_mov_b32 s6, 28311552
  s_mov_b32 s7, 0x20000
  s_mov_b32 s12, s54
  s_mov_b32 s13, s55
  s_mov_b32 s14, 0
  s_mov_b32 s15, 0x20000
  s_lshl_b32 s97, s24, 2
  s_waitcnt lgkmcnt(0)
  s_branch concat_heads__linear_kernel_hedgehog__softmax_full_mha__prompt_kernel_att
concat_heads__linear_kernel_hedgehog__softmax_full_mha__prompt_kernel_pre:
  s_barrier
  s_waitcnt lgkmcnt(0)
  s_mov_b32 s4, s54
  s_mov_b32 s5, s55
  s_mov_b32 s6, 28311552
  s_mov_b32 s7, 0x20000
  s_mov_b32 s12, s54
  s_mov_b32 s13, s55
  s_mov_b32 s14, 0
  s_mov_b32 s15, 0x20000
  s_lshl_b32 s97, s24, 2
  v_mov_b32 v20, 27918336
  buffer_load_dword v20, v20, s[4:7], 0 offen sc1
  s_and_b32 s56, s24, 3
  s_and_b32 s57, s32, 1
  s_lshl_b32 s58, s57, 10
  s_sub_u32 s58, s58, 64
  s_lshl_b32 s57, s57, 5
  s_add_u32 s57, s57, 2048
  s_lshl_b32 s59, s56, 6
  s_add_u32 s59, s59, 0
  v_add_u32 v2, s59, v0
  v_mul_u32_u24 v3, 911, v2
  v_lshrrev_b32 v3, 16, v3
  v_mul_u32_u24 v4, 72, v3
  v_sub_u32 v4, v2, v4
  v_lshl_add_u32 v5, v4, 4, s58
  v_bfe_u32 v6, v4, 1, 1
  v_and_b32 v7, 1, v4
  v_lshlrev_b32 v7, 4, v7
  v_lshl_add_u32 v6, v6, 6, v7
  v_lshrrev_b32 v7, 6, v4
  v_lshl_add_u32 v6, v7, 7, v6
  v_add_u32 v6, s57, v6
  v_add_u32 v4, -4, v4
  v_cmp_gt_u32 vcc, 64, v4
  v_mul_u32_u24 v3, 2304, v3
  s_nop 0
  v_cndmask_b32 v5, v6, v5, vcc
  v_add_u32 v158, v5, v3
  s_lshl_b32 s59, s56, 6
  s_add_u32 s59, s59, 256
  v_add_u32 v2, s59, v0
  v_mul_u32_u24 v3, 911, v2
  v_lshrrev_b32 v3, 16, v3
  v_mul_u32_u24 v4, 72, v3
  v_sub_u32 v4, v2, v4
  v_lshl_add_u32 v5, v4, 4, s58
  v_bfe_u32 v6, v4, 1, 1
  v_and_b32 v7, 1, v4
  v_lshlrev_b32 v7, 4, v7
  v_lshl_add_u32 v6, v6, 6, v7
  v_lshrrev_b32 v7, 6, v4
  v_lshl_add_u32 v6, v7, 7, v6
  v_add_u32 v6, s57, v6
  v_add_u32 v4, -4, v4
  v_cmp_gt_u32 vcc, 64, v4
  v_mul_u32_u24 v3, 2304, v3
  s_nop 0
  v_cndmask_b32 v5, v6, v5, vcc
  v_add_u32 v159, v5, v3
  s_mov_b32 s59, 512
  v_add_u32 v2, s59, v0
  v_mul_u32_u24 v3, 911, v2
  v_lshrrev_b32 v3, 16, v3
  v_mul_u32_u24 v4, 72, v3
  v_sub_u32 v4, v2, v4
  v_lshl_add_u32 v5, v4, 4, s58
  v_bfe_u32 v6, v4, 1, 1
  v_and_b32 v7, 1, v4
  v_lshlrev_b32 v7, 4, v7
  v_lshl_add_u32 v6, v6, 6, v7
  v_lshrrev_b32 v7, 6, v4
  v_lshl_add_u32 v6, v7, 7, v6
  v_add_u32 v6, s57, v6
  v_add_u32 v4, -4, v4
  v_cmp_gt_u32 vcc, 64, v4
  v_mul_u32_u24 v3, 2304, v3
  s_nop 0
  v_cndmask_b32 v5, v6, v5, vcc
  v_add_u32 v160, v5, v3
  s_cmp_eq_u32 s56, 0
  s_cselect_b64 vcc, -1, 0
  s_nop 0
  v_cndmask_b32 v160, v1, v160, vcc
  s_mul_i32 s56, s32, 18
  s_add_u32 s57, s56, 593
  s_lshr_b32 s57, s57, 7
  s_add_u32 s56, s56, 576
  s_lshr_b32 s56, s56, 7
  s_mul_i32 s58, s32, 18
  s_add_u32 s59, s58, 1169
  s_lshr_b32 s59, s59, 7
  s_add_u32 s58, s58, 1152
  s_lshr_b32 s58, s58, 7
  v_mov_b32 v2, s56
  v_mov_b32 v3, s58
  v_cmp_gt_u32 vcc, 32, v0
  v_mov_b32 v4, s57
  v_mov_b32 v5, s59
  v_cndmask_b32 v2, v3, v2, vcc
  v_cndmask_b32 v4, v5, v4, vcc
  v_bfe_u32 v3, v0, 4, 1
  v_cmp_eq_u32 vcc, 0, v3
  v_and_b32 v3, 15, v0
  s_nop 0
  v_cndmask_b32 v2, v4, v2, vcc
  v_lshl_add_u32 v2, v3, 4, v2
  v_lshlrev_b32 v2, 7, v2
  v_add_u32 v140, 27262976, v2
  s_mul_i32 s56, s32, 18
  s_add_u32 s57, s56, 17
  s_lshr_b32 s57, s57, 7
  s_add_u32 s56, s56, 0
  s_lshr_b32 s56, s56, 7
  v_mov_b32 v2, s56
  v_mov_b32 v4, s57
  v_cmp_gt_u32 vcc, 32, v0
  s_lshl_b32 s59, s33, 1
  v_and_or_b32 v3, v0, 1, s59
  v_cndmask_b32 v2, v4, v2, vcc
  v_lshl_add_u32 v2, v3, 4, v2
  v_lshlrev_b32 v2, 7, v2
  v_add_u32 v141, 27262976, v2
  s_cmp_eq_u32 s24, 9
  s_cselect_b64 vcc, -1, 0
  s_nop 0
  v_cndmask_b32 v140, v140, v141, vcc
  s_lshl_b32 s62, s32, 16
  s_add_u32 s62, s62, 10485760
  s_lshr_b32 s56, s32, 1
  s_mul_i32 s63, s56, 147456
  s_add_u32 s63, s63, 12582912
  s_lshl_b32 s66, s56, 14
  s_add_u32 s64, s66, 15466496
  s_and_b32 s56, s24, 3
  s_lshl_b32 s57, s56, 10
  s_min_u32 s58, s56, 2
  s_lshl_b32 s35, s58, 10
  s_add_u32 s67, s35, s64
  s_sub_u32 s67, s67, 1024
  s_add_u32 s35, s35, 35840
  s_cmp_eq_u32 s56, 0
  s_cselect_b32 s67, s63, s67
  s_movk_i32 s96, 256
  s_cselect_b32 s96, 2304, s96
  s_mov_b32 s58, 1
  s_mul_i32 s27, s58, 19456
  s_add_u32 s27, s27, s57
  s_mul_i32 s68, s58, 32768
  s_add_u32 s68, s68, s57
  s_add_u32 s68, s68, s62
  s_mul_i32 s69, s58, 73728
  s_add_u32 s69, s69, s63
  s_lshl_b32 s58, s33, 3
  s_lshl_b32 s56, s56, 1
  s_add_u32 s65, s58, s56
  s_lshl_b32 s56, s65, 8
  s_add_u32 s66, s66, s56
  s_add_u32 s66, s66, 15204352
  s_mul_i32 s3, s33, 144
  s_waitcnt vmcnt(0)
  v_readfirstlane_b32 s25, v20
  s_add_u32 s25, s25, 1
  s_xor_b32 s26, s25, 0x5bd1e995
  v_and_b32 v2, 3, v0
  v_lshlrev_b32 v2, 2, v2
  v_add_u32 v2, 161728, v2
  s_mov_b32 s61, 1048576
concat_heads__linear_kernel_hedgehog__softmax_full_mha__prompt_kernel_gb_1:
  ds_read_b32 v3, v2
  s_sub_u32 s61, s61, 1
  s_waitcnt lgkmcnt(0)
  s_cbranch_scc1 concat_heads__linear_kernel_hedgehog__softmax_full_mha__prompt_kernel_gb_1x
  v_cmp_ne_u32 vcc, 0, v3
  s_cbranch_vccz concat_heads__linear_kernel_hedgehog__softmax_full_mha__prompt_kernel_gb_1x
  s_sleep 2
  s_branch concat_heads__linear_kernel_hedgehog__softmax_full_mha__prompt_kernel_gb_1
concat_heads__linear_kernel_hedgehog__softmax_full_mha__prompt_kernel_gb_1x:
  s_lshl_b32 s56, s30, 4
  s_add_u32 s56, s56, s31
  s_lshl_b32 s56, s56, 7
  s_add_u32 s56, s56, 27262976
  s_cmp_eq_u32 s24, 10
  s_cbranch_scc0 concat_heads__linear_kernel_hedgehog__softmax_full_mha__prompt_kernel_nfl
  v_mov_b32 v136, s25
  v_mov_b32 v137, s26
  v_mov_b32 v138, s25
  v_mov_b32 v139, s26
  s_mov_b64 exec, 0xff
  buffer_store_dwordx4 v[136:139], v1, s[4:7], s56 offen sc1
  s_mov_b64 exec, -1
  s_nop 0
concat_heads__linear_kernel_hedgehog__softmax_full_mha__prompt_kernel_nfl:
  s_cmp_lt_u32 s24, 10
  s_cbranch_scc0 concat_heads__linear_kernel_hedgehog__softmax_full_mha__prompt_kernel_fgbx
  s_cmp_eq_u32 s31, 15
  s_cbranch_scc1 concat_heads__linear_kernel_hedgehog__softmax_full_mha__prompt_kernel_nps
  v_and_b32 v2, 3, v0
  v_lshlrev_b32 v2, 2, v2
  v_add_u32 v2, 161008, v2
  s_mov_b32 s61, 1048576
concat_heads__linear_kernel_hedgehog__softmax_full_mha__prompt_kernel_gb_2:
  ds_read_b32 v3, v2
  s_sub_u32 s61, s61, 1
  s_waitcnt lgkmcnt(0)
  s_cbranch_scc1 concat_heads__linear_kernel_hedgehog__softmax_full_mha__prompt_kernel_gb_2x
  v_cmp_ne_u32 vcc, 0, v3
  s_cbranch_vccz concat_heads__linear_kernel_hedgehog__softmax_full_mha__prompt_kernel_gb_2x
  s_sleep 2
  s_branch concat_heads__linear_kernel_hedgehog__softmax_full_mha__prompt_kernel_gb_2
concat_heads__linear_kernel_hedgehog__softmax_full_mha__prompt_kernel_gb_2x:
concat_heads__linear_kernel_hedgehog__softmax_full_mha__prompt_kernel_nps:
  buffer_load_dwordx2 v[138:139], v140, s[4:7], 0 offen sc1
  s_waitcnt vmcnt(0)
  s_mov_b32 s61, 1048576
concat_heads__linear_kernel_hedgehog__softmax_full_mha__prompt_kernel_plp_4:
  v_cmp_eq_u32 vcc, s25, v138
  v_cmp_eq_u32 s[94:95], s26, v139
  s_and_b64 vcc, vcc, s[94:95]
  s_cmp_eq_u64 vcc, -1
  s_cbranch_scc1 concat_heads__linear_kernel_hedgehog__softmax_full_mha__prompt_kernel_pok_3
  s_sub_u32 s61, s61, 1
  s_cbranch_scc1 concat_heads__linear_kernel_hedgehog__softmax_full_mha__prompt_kernel_pok_3
  buffer_load_dwordx2 v[138:139], v140, s[4:7], 0 offen sc1
  s_waitcnt vmcnt(0)
  s_branch concat_heads__linear_kernel_hedgehog__softmax_full_mha__prompt_kernel_plp_4
concat_heads__linear_kernel_hedgehog__softmax_full_mha__prompt_kernel_pok_3:
  s_add_u32 m0, s97, 161680
  s_mov_b64 exec, 1
  buffer_load_dword v0, s[12:15], 0 offen lds
  s_mov_b64 exec, -1
concat_heads__linear_kernel_hedgehog__softmax_full_mha__prompt_kernel_fgbx:
  s_cmp_eq_u32 s31, 15
  s_cbranch_scc1 concat_heads__linear_kernel_hedgehog__softmax_full_mha__prompt_kernel_nfr
  v_and_b32 v2, 3, v0
  v_lshlrev_b32 v2, 2, v2
  v_add_u32 v2, 161056, v2
  s_mov_b32 s61, 1048576
concat_heads__linear_kernel_hedgehog__softmax_full_mha__prompt_kernel_gb_5:
  ds_read_b32 v3, v2
  s_sub_u32 s61, s61, 1
  s_waitcnt lgkmcnt(0)
  s_cbranch_scc1 concat_heads__linear_kernel_hedgehog__softmax_full_mha__prompt_kernel_gb_5x
  v_cmp_ne_u32 vcc, 0, v3
  s_cbranch_vccz concat_heads__linear_kernel_hedgehog__softmax_full_mha__prompt_kernel_gb_5x
  s_sleep 2
  s_branch concat_heads__linear_kernel_hedgehog__softmax_full_mha__prompt_kernel_gb_5
concat_heads__linear_kernel_hedgehog__softmax_full_mha__prompt_kernel_gb_5x:
concat_heads__linear_kernel_hedgehog__softmax_full_mha__prompt_kernel_nfr:
  v_and_b32 v2, 1, v0
  v_lshlrev_b32 v2, 2, v2
  v_add_u32 v2, 161712, v2
  s_mov_b32 s61, 1048576
concat_heads__linear_kernel_hedgehog__softmax_full_mha__prompt_kernel_gb_6:
  ds_read_b32 v3, v2
  s_sub_u32 s61, s61, 1
  s_waitcnt lgkmcnt(0)
  s_cbranch_scc1 concat_heads__linear_kernel_hedgehog__softmax_full_mha__prompt_kernel_gb_6x
  v_cmp_ne_u32 vcc, 0, v3
  s_cbranch_vccz concat_heads__linear_kernel_hedgehog__softmax_full_mha__prompt_kernel_gb_6x
  s_sleep 2
  s_branch concat_heads__linear_kernel_hedgehog__softmax_full_mha__prompt_kernel_gb_6
concat_heads__linear_kernel_hedgehog__softmax_full_mha__prompt_kernel_gb_6x:
  s_sub_u32 s57, s24, 8
  s_lshl_b32 s58, s57, 11
  s_add_u32 m0, s58, 38912
  s_lshl_b32 s59, s32, 6
  s_lshl_b32 s60, s33, 3
  s_add_u32 s59, s59, s60
  s_lshl_b32 s59, s59, 10
  s_add_u32 s59, s59, s58
  s_add_u32 s59, s59, 8388608
  buffer_load_dwordx4 v1, s[4:7], s59 offen sc1 lds
  buffer_load_dwordx4 v1, s[4:7], s59 offen offset:1024 sc1 lds
  s_and_b32 s57, s57, 1
  s_lshl_b32 s57, s57, 10
  s_add_u32 m0, s57, 47104
  s_lshl_b32 s60, s60, 8
  s_add_u32 s60, s60, s64
  s_add_u32 s60, s60, s57
  s_sub_u32 s60, s60, 262144
  buffer_load_dwordx4 v1, s[4:7], s60 offen sc1 lds
  s_add_u32 m0, s27, 4294947840
  s_add_u32 s56, s68, 4294934528
  buffer_load_dwordx4 v1, s[4:7], s56 offen sc1 lds
  s_add_u32 m0, s27, 0
  s_add_u32 s56, s68, 0
  buffer_load_dwordx4 v1, s[4:7], s56 offen sc1 lds
  s_add_u32 m0, s27, 4294951936
  s_add_u32 s56, s68, 4294938624
  buffer_load_dwordx4 v1, s[4:7], s56 offen sc1 lds
  s_add_u32 m0, s27, 4096
  s_add_u32 s56, s68, 4096
  buffer_load_dwordx4 v1, s[4:7], s56 offen sc1 lds
  s_add_u32 m0, s27, 4294956032
  s_add_u32 s56, s69, 4294893568
  buffer_load_dwordx4 v158, s[4:7], s56 offen sc1 lds
  s_add_u32 m0, s27, 8192
  s_add_u32 s56, s69, 0
  buffer_load_dwordx4 v158, s[4:7], s56 offen sc1 lds
  s_add_u32 m0, s27, 4294960128
  s_add_u32 s56, s69, 4294893568
  buffer_load_dwordx4 v159, s[4:7], s56 offen sc1 lds
  s_add_u32 m0, s27, 12288
  s_add_u32 s56, s69, 0
  buffer_load_dwordx4 v159, s[4:7], s56 offen sc1 lds
  s_add_u32 m0, s35, 4294947840
  s_mul_i32 s56, s96, 0
  s_add_u32 s56, s56, s67
  buffer_load_dwordx4 v160, s[4:7], s56 offen sc1 lds
  s_add_u32 m0, s35, 0
  s_mul_i32 s56, s96, 32
  s_add_u32 s56, s56, s67
  buffer_load_dwordx4 v160, s[4:7], s56 offen sc1 lds
  s_add_u32 m0, s97, 161376
  s_mov_b64 exec, 1
  buffer_load_dword v0, s[12:15], 0 offen lds
  s_mov_b64 exec, -1
  s_branch concat_heads__linear_kernel_hedgehog__softmax_full_mha__prompt_kernel_att
concat_heads__linear_kernel_hedgehog__softmax_full_mha__prompt_kernel_gc:
  s_lshr_b32 s68, s24, 1
  s_and_b32 s69, s24, 1
  s_lshl_b32 s56, s24, 8
  v_lshl_add_u32 v2, v0, 2, s56
  v_cmp_le_u32 vcc, 64, v2
  v_add_u32 v2, 160768, v2
  v_and_b32 v145, 3, v0
  v_cndmask_b32 v4, 0, 1, vcc
  ds_write_b32 v2, v4
  v_lshlrev_b32 v145, 2, v145
  v_add_u32 v145, 161120, v145
  s_lshl_b32 s101, s24, 2
  s_add_u32 s101, s101, 160832
  s_waitcnt lgkmcnt(0)
  s_barrier
  s_setprio 2
  s_mov_b32 s4, s54
  s_mov_b32 s5, s55
  s_mov_b32 s6, 28311552
  s_mov_b32 s7, 0x20000
  s_mov_b32 s12, s54
  s_mov_b32 s13, s55
  s_mov_b32 s14, 0
  s_mov_b32 s15, 0x20000
  s_lshl_b32 s97, s24, 2
  v_mov_b32 v157, 27918336
  buffer_load_dword v157, v157, s[4:7], 0 offen sc1
  s_mov_b32 s20, s40
  s_mov_b32 s21, s41
  s_mov_b32 s22, 20736
  s_mov_b32 s23, 0x20000
  s_and_b32 s56, s32, 1
  s_mul_i32 s57, s56, 72
  s_mul_i32 s58, s32, 648
  s_add_u32 s57, s57, s58
  s_cmp_eq_u32 s56, 0
  s_cselect_b32 s56, 576, 0
  s_add_u32 s58, s58, s56
  v_mov_b32 v2, 0x7fffff00
  v_cmp_eq_u32 vcc, 20, v9
  v_lshlrev_b32 v3, 1, v9
  v_mul_u32_u24 v4, 144, v8
  v_cndmask_b32 v2, v2, 34, vcc
  v_cmp_ge_u32 vcc, 16, v9
  v_mov_b32 v153, 0
  s_nop 0
  v_cndmask_b32 v2, v2, v3, vcc
  v_add_u32 v3, v2, v4
  v_lshl_add_u32 v2, v8, 30, v2
  buffer_load_ushort v116, v3, s[20:23], s57 offen offset:0
  buffer_load_ushort v117, v3, s[20:23], s57 offen offset:36
  buffer_load_ushort v118, v3, s[20:23], s57 offen offset:72
  buffer_load_ushort v119, v3, s[20:23], s57 offen offset:108
  buffer_load_ushort v120, v3, s[20:23], s57 offen offset:288
  buffer_load_ushort v121, v3, s[20:23], s57 offen offset:324
  buffer_load_ushort v122, v3, s[20:23], s57 offen offset:360
  buffer_load_ushort v123, v3, s[20:23], s57 offen offset:396
  buffer_load_ushort v124, v2, s[20:23], s58 offen offset:0
  buffer_load_ushort v125, v2, s[20:23], s58 offen offset:36
  s_and_b32 s56, s24, 3
  s_and_b32 s57, s32, 1
  s_lshl_b32 s58, s57, 10
  s_sub_u32 s58, s58, 64
  s_lshl_b32 s57, s57, 5
  s_add_u32 s57, s57, 2048
  s_lshl_b32 s59, s56, 6
  s_add_u32 s59, s59, 0
  v_add_u32 v2, s59, v0
  v_mul_u32_u24 v3, 911, v2
  v_lshrrev_b32 v3, 16, v3
  v_mul_u32_u24 v4, 72, v3
  v_sub_u32 v4, v2, v4
  v_lshl_add_u32 v5, v4, 4, s58
  v_bfe_u32 v6, v4, 1, 1
  v_and_b32 v7, 1, v4
  v_lshlrev_b32 v7, 4, v7
  v_lshl_add_u32 v6, v6, 6, v7
  v_lshrrev_b32 v7, 6, v4
  v_lshl_add_u32 v6, v7, 7, v6
  v_add_u32 v6, s57, v6
  v_add_u32 v4, -4, v4
  v_cmp_gt_u32 vcc, 64, v4
  v_mul_u32_u24 v3, 2304, v3
  s_nop 0
  v_cndmask_b32 v5, v6, v5, vcc
  v_add_u32 v154, v5, v3
  s_lshl_b32 s59, s56, 6
  s_add_u32 s59, s59, 256
  v_add_u32 v2, s59, v0
  v_mul_u32_u24 v3, 911, v2
  v_lshrrev_b32 v3, 16, v3
  v_mul_u32_u24 v4, 72, v3
  v_sub_u32 v4, v2, v4
  v_lshl_add_u32 v5, v4, 4, s58
  v_bfe_u32 v6, v4, 1, 1
  v_and_b32 v7, 1, v4
  v_lshlrev_b32 v7, 4, v7
  v_lshl_add_u32 v6, v6, 6, v7
  v_lshrrev_b32 v7, 6, v4
  v_lshl_add_u32 v6, v7, 7, v6
  v_add_u32 v6, s57, v6
  v_add_u32 v4, -4, v4
  v_cmp_gt_u32 vcc, 64, v4
  v_mul_u32_u24 v3, 2304, v3
  s_nop 0
  v_cndmask_b32 v5, v6, v5, vcc
  v_add_u32 v155, v5, v3
  s_mov_b32 s59, 512
  v_add_u32 v2, s59, v0
  v_mul_u32_u24 v3, 911, v2
  v_lshrrev_b32 v3, 16, v3
  v_mul_u32_u24 v4, 72, v3
  v_sub_u32 v4, v2, v4
  v_lshl_add_u32 v5, v4, 4, s58
  v_bfe_u32 v6, v4, 1, 1
  v_and_b32 v7, 1, v4
  v_lshlrev_b32 v7, 4, v7
  v_lshl_add_u32 v6, v6, 6, v7
  v_lshrrev_b32 v7, 6, v4
  v_lshl_add_u32 v6, v7, 7, v6
  v_add_u32 v6, s57, v6
  v_add_u32 v4, -4, v4
  v_cmp_gt_u32 vcc, 64, v4
  v_mul_u32_u24 v3, 2304, v3
  s_nop 0
  v_cndmask_b32 v5, v6, v5, vcc
  v_add_u32 v156, v5, v3
  s_cmp_eq_u32 s56, 0
  s_cselect_b64 vcc, -1, 0
  s_nop 0
  v_cndmask_b32 v156, v1, v156, vcc
  s_lshl_b32 s59, s24, 6
  v_add_u32 v2, s59, v0
  v_mul_u32_u24 v3, 7282, v2
  v_lshrrev_b32 v3, 16, v3
  v_mul_u32_u24 v4, 9, v3
  v_sub_u32 v4, v2, v4
  v_lshlrev_b32 v4, 4, v4
  v_lshrrev_b32 v5, 4, v3
  v_bfe_u32 v6, v3, 2, 2
  v_bfe_u32 v7, v3, 1, 1
  v_and_b32 v3, 1, v3
  v_and_b32 v2, 1, v5
  v_mad_u32_u24 v2, v5, 9, v2
  v_lshl_add_u32 v2, v2, 1, v6
  v_lshl_add_u32 v2, v3, 3, v2
  v_lshl_add_u32 v2, v7, 2, v2
  v_mul_u32_u24 v2, 1152, v2
  v_add_u32 v160, v2, v4
  v_lshlrev_b32 v2, 3, v5
  v_lshl_add_u32 v2, v7, 2, v2
  v_lshl_add_u32 v2, v3, 1, v2
  v_lshrrev_b32 v3, 1, v6
  v_add_u32 v2, v2, v3
  v_mul_u32_u24 v2, 18, v2
  v_xor_b32 v3, 1, v3
  v_lshl_add_u32 v2, v3, 4, v2
  v_and_b32 v6, 1, v6
  v_add_u32 v2, v2, v6
  v_mul_u32_u24 v2, 1152, v2
  v_add_u32 v163, v2, v4
  s_lshl_b32 s59, s24, 6
  s_add_u32 s59, s59, 256
  v_add_u32 v2, s59, v0
  v_mul_u32_u24 v3, 7282, v2
  v_lshrrev_b32 v3, 16, v3
  v_mul_u32_u24 v4, 9, v3
  v_sub_u32 v4, v2, v4
  v_lshlrev_b32 v4, 4, v4
  v_lshrrev_b32 v5, 4, v3
  v_bfe_u32 v6, v3, 2, 2
  v_bfe_u32 v7, v3, 1, 1
  v_and_b32 v3, 1, v3
  v_and_b32 v2, 1, v5
  v_mad_u32_u24 v2, v5, 9, v2
  v_lshl_add_u32 v2, v2, 1, v6
  v_lshl_add_u32 v2, v3, 3, v2
  v_lshl_add_u32 v2, v7, 2, v2
  v_mul_u32_u24 v2, 1152, v2
  v_add_u32 v161, v2, v4
  v_lshlrev_b32 v2, 3, v5
  v_lshl_add_u32 v2, v7, 2, v2
  v_lshl_add_u32 v2, v3, 1, v2
  v_lshrrev_b32 v3, 1, v6
  v_add_u32 v2, v2, v3
  v_mul_u32_u24 v2, 18, v2
  v_xor_b32 v3, 1, v3
  v_lshl_add_u32 v2, v3, 4, v2
  v_and_b32 v6, 1, v6
  v_add_u32 v2, v2, v6
  v_mul_u32_u24 v2, 1152, v2
  v_add_u32 v164, v2, v4
  s_mov_b32 s59, 512
  v_add_u32 v2, s59, v0
  v_mul_u32_u24 v3, 7282, v2
  v_lshrrev_b32 v3, 16, v3
  v_mul_u32_u24 v4, 9, v3
  v_sub_u32 v4, v2, v4
  v_lshlrev_b32 v4, 4, v4
  v_lshrrev_b32 v5, 4, v3
  v_bfe_u32 v6, v3, 2, 2
  v_bfe_u32 v7, v3, 1, 1
  v_and_b32 v3, 1, v3
  v_and_b32 v2, 1, v5
  v_mad_u32_u24 v2, v5, 9, v2
  v_lshl_add_u32 v2, v2, 1, v6
  v_lshl_add_u32 v2, v3, 3, v2
  v_lshl_add_u32 v2, v7, 2, v2
  v_mul_u32_u24 v2, 1152, v2
  v_add_u32 v162, v2, v4
  v_lshlrev_b32 v2, 3, v5
  v_lshl_add_u32 v2, v7, 2, v2
  v_lshl_add_u32 v2, v3, 1, v2
  v_lshrrev_b32 v3, 1, v6
  v_add_u32 v2, v2, v3
  v_mul_u32_u24 v2, 18, v2
  v_xor_b32 v3, 1, v3
  v_lshl_add_u32 v2, v3, 4, v2
  v_and_b32 v6, 1, v6
  v_add_u32 v2, v2, v6
  v_mul_u32_u24 v2, 1152, v2
  v_add_u32 v165, v2, v4
  v_bfe_u32 v2, v0, 2, 2
  v_min_u32 v2, 2, v2
  v_mul_u32_u24 v2, 576, v2
  v_bfe_u32 v3, v0, 1, 1
  v_mad_u32_u24 v2, v3, 17, v2
  s_mul_i32 s56, s32, 18
  v_add_u32 v2, s56, v2
  v_lshrrev_b32 v2, 7, v2
  v_and_b32 v3, 1, v0
  v_lshl_add_u32 v2, v2, 2, v3
  s_lshl_b32 s56, s33, 1
  s_lshr_b32 s57, s24, 1
  s_add_u32 s56, s56, s57
  s_lshl_b32 s56, s56, 6
  s_and_b32 s57, s24, 1
  s_lshl_b32 s57, s57, 1
  s_add_u32 s56, s56, s57
  v_add_u32 v2, s56, v2
  v_lshlrev_b32 v2, 7, v2
  v_add_u32 v166, 27394048, v2
  s_and_b32 s61, s32, 1
  s_lshl_b32 s61, s61, 5
  v_lshlrev_b32 v158, 6, v8
  v_lshl_add_u32 v158, v9, 4, v158
  v_add_u32 v158, s61, v158
  v_add_u32 v158, 1792, v158
  s_lshl_b32 s61, s61, 5
  v_lshlrev_b32 v159, 8, v8
  v_lshl_add_u32 v159, v9, 4, v159
  v_cmp_gt_u32 vcc, 16, v9
  v_add_u32 v159, s61, v159
  s_nop 0
  v_cndmask_b32 v158, v158, v159, vcc
  v_mov_b32 v159, 128
  v_cndmask_b32 v159, v159, 0, vcc
  v_cndmask_b32 v2, 0, 1, vcc
  v_lshl_add_u32 v159, v2, 9, v159
  v_add_u32 v159, v158, v159
  s_and_b32 s61, s32, 1
  s_lshl_b32 s61, s61, 2
  v_lshl_add_u32 v167, v9, 3, s61
  s_cmp_eq_u32 s31, 15
  s_cbranch_scc0 concat_heads__linear_kernel_hedgehog__softmax_full_mha__prompt_kernel_zact
  s_and_b32 s57, s2, 31
  s_lshl_b32 s57, s57, 2
  s_add_u32 s57, s57, s24
  s_sub_u32 s57, s57, 0
  v_lshlrev_b32 v2, 7, v0
  s_waitcnt vmcnt(0)
  v_lshl_or_b32 v148, v117, 16, v116
  v_lshl_or_b32 v149, v119, 16, v118
  v_lshl_or_b32 v150, v121, 16, v120
  v_lshl_or_b32 v151, v123, 16, v122
  v_lshl_or_b32 v152, v125, 16, v124
  s_add_u32 m0, s97, 161728
  s_mov_b64 exec, 1
  buffer_load_dword v0, s[12:15], 0 offen lds
  s_mov_b64 exec, -1
  s_branch concat_heads__linear_kernel_hedgehog__softmax_full_mha__prompt_kernel_gdone
concat_heads__linear_kernel_hedgehog__softmax_full_mha__prompt_kernel_zact:
  s_mov_b32 s56, 688267392
  s_mov_b32 s10, 912184
  s_mov_b32 s11, 1047484
  s_cmp_eq_u32 s31, 0
  s_cselect_b32 s56, 930691365, s56
  s_cselect_b32 s10, 100384, s10
  s_cselect_b32 s11, 1038756, s11
  s_cmp_eq_u32 s31, 1
  s_cselect_b32 s56, 757507200, s56
  s_cselect_b32 s10, 911912, s10
  s_cselect_b32 s11, 1047484, s11
  s_cmp_eq_u32 s31, 2
  s_cselect_b32 s56, 896054532, s56
  s_cselect_b32 s10, 100384, s10
  s_cselect_b32 s11, 1047212, s11
  s_cmp_eq_u32 s31, 3
  s_cselect_b32 s56, 722871107, s56
  s_cselect_b32 s10, 231456, s10
  s_cselect_b32 s11, 1047344, s11
  s_cmp_eq_u32 s31, 4
  s_cselect_b32 s56, 861417699, s56
  s_cselect_b32 s10, 362528, s10
  s_cselect_b32 s11, 1047476, s11
  s_cmp_eq_u32 s31, 5
  s_cselect_b32 s56, 688234274, s56
  s_cselect_b32 s10, 497696, s10
  s_cselect_b32 s11, 1047480, s11
  s_cmp_eq_u32 s31, 6
  s_cselect_b32 s56, 826780866, s56
  s_cselect_b32 s10, 632864, s10
  s_cselect_b32 s11, 1047484, s11
  s_cmp_eq_u32 s31, 7
  s_cselect_b32 s56, 965328198, s56
  s_cselect_b32 s10, 100384, s10
  s_cselect_b32 s11, 768164, s11
  s_cmp_eq_u32 s31, 8
  s_cselect_b32 s56, 792144033, s56
  s_cselect_b32 s10, 903456, s10
  s_cselect_b32 s11, 1047484, s11
  s_mul_i32 s57, s69, 20
  s_lshr_b32 s56, s56, s57
  s_bfe_u32 s62, s56, 327680
  s_bfe_u32 s64, s56, 327685
  s_bfe_u32 s63, s56, 327690
  s_bfe_u32 s65, s56, 327695
  v_bfe_u32 v12, v0, 1, 3
  s_lshl_b32 s56, s68, 13
  s_add_u32 s56, s56, 95232
  v_lshl_add_u32 v13, v9, 7, s56
  v_or_b32 v14, 0, v8
  v_xor_b32 v14, v14, v12
  v_lshl_add_u32 v2, v14, 4, v13
  v_or_b32 v14, 2, v8
  v_xor_b32 v14, v14, v12
  v_lshl_add_u32 v3, v14, 4, v13
  v_or_b32 v14, 4, v8
  v_xor_b32 v14, v14, v12
  v_lshl_add_u32 v4, v14, 4, v13
  v_or_b32 v14, 6, v8
  v_xor_b32 v14, v14, v12
  v_lshl_add_u32 v5, v14, 4, v13
  v_bfe_u32 v11, v0, 2, 2
  v_lshl_add_u32 v12, v8, 3, v11
  v_lshlrev_b32 v12, 8, v12
  v_add_u32 v12, 111616, v12
  v_lshlrev_b32 v11, 2, v11
  v_and_b32 v13, 3, v0
  v_bfe_u32 v14, v0, 4, 1
  v_cmp_eq_u32 vcc, 0, v14
  v_mov_b32 v15, s64
  v_mov_b32 v16, s62
  v_cndmask_b32 v15, v15, v16, vcc
  v_add_u32 v15, v15, v13
  s_cmp_ge_u32 s31, 9
  s_cbranch_scc0 concat_heads__linear_kernel_hedgehog__softmax_full_mha__prompt_kernel_wa0
  v_lshl_add_u32 v15, v14, 2, v13
  s_lshl_b32 s56, s69, 4
  v_add_u32 v15, s56, v15
concat_heads__linear_kernel_hedgehog__softmax_full_mha__prompt_kernel_wa0:
  v_lshrrev_b32 v16, 1, v15
  v_xor_b32 v16, v16, v11
  v_lshl_add_u32 v16, v16, 4, v12
  v_and_b32 v15, 1, v15
  v_lshl_add_u32 v6, v15, 3, v16
  v_mov_b32 v15, s65
  v_mov_b32 v16, s63
  v_cndmask_b32 v15, v15, v16, vcc
  v_add_u32 v15, v15, v13
  s_cmp_eq_u32 s69, 0
  s_cbranch_scc1 concat_heads__linear_kernel_hedgehog__softmax_full_mha__prompt_kernel_wa1
  v_mov_b32 v15, s11
  v_mov_b32 v16, s10
  v_cndmask_b32 v15, v15, v16, vcc
  v_mul_u32_u24 v16, 5, v13
  v_bfe_u32 v15, v15, v16, 5
  s_branch concat_heads__linear_kernel_hedgehog__softmax_full_mha__prompt_kernel_wa2
concat_heads__linear_kernel_hedgehog__softmax_full_mha__prompt_kernel_wa1:
  s_cmp_ge_u32 s31, 9
  s_cbranch_scc0 concat_heads__linear_kernel_hedgehog__softmax_full_mha__prompt_kernel_wa2
  v_lshl_add_u32 v15, v14, 2, v13
  v_add_u32 v15, 8, v15
concat_heads__linear_kernel_hedgehog__softmax_full_mha__prompt_kernel_wa2:
  v_lshrrev_b32 v16, 1, v15
  v_xor_b32 v16, v16, v11
  v_lshl_add_u32 v16, v16, 4, v12
  v_and_b32 v15, 1, v15
  v_lshl_add_u32 v7, v15, 3, v16
  s_lshl_b32 s56, s31, 5
  s_add_u32 s56, s56, s62
  s_mul_i32 s57, s56, 57
  s_lshr_b32 s57, s57, 9
  s_mul_i32 s58, s57, 9
  s_cmp_lg_u32 s58, s56
  s_addc_u32 s62, s57, s57
  s_lshl_b32 s56, s31, 5
  s_add_u32 s56, s56, s64
  s_mul_i32 s57, s56, 57
  s_lshr_b32 s57, s57, 9
  s_mul_i32 s58, s57, 9
  s_cmp_lg_u32 s58, s56
  s_addc_u32 s64, s57, s57
  s_lshl_b32 s56, s31, 5
  s_add_u32 s56, s56, s63
  s_mul_i32 s57, s56, 57
  s_lshr_b32 s57, s57, 9
  s_mul_i32 s58, s57, 9
  s_cmp_lg_u32 s58, s56
  s_addc_u32 s63, s57, s57
  s_lshl_b32 s56, s31, 5
  s_add_u32 s56, s56, s65
  s_mul_i32 s57, s56, 57
  s_lshr_b32 s57, s57, 9
  s_mul_i32 s58, s57, 9
  s_cmp_lg_u32 s58, s56
  s_addc_u32 s65, s57, s57
  s_mov_b32 s27, 4294868992
  s_mov_b32 s35, 32768
  s_mov_b32 s67, 2
  s_mov_b32 s66, 0
  s_mov_b32 s34, 1
  s_lshl_b32 s98, s30, 2
  s_lshl_b32 s56, s68, 1
  s_add_u32 s98, s98, s56
  s_mov_b32 s100, 1051597459
  v_and_b32 v12, 19, v9
  v_lshrrev_b32 v11, 1, v9
  v_and_b32 v11, 4, v11
  v_or_b32 v12, v12, v11
  v_lshlrev_b32 v11, 1, v9
  v_and_b32 v11, 8, v11
  v_or_b32 v12, v12, v11
  v_lshl_add_u32 v11, v8, 5, v12
  v_lshlrev_b32 v11, 3, v11
  v_cmp_eq_u32 s[28:29], 0, v8
  s_waitcnt vmcnt(0)
  v_lshl_or_b32 v148, v117, 16, v116
  v_lshl_or_b32 v149, v119, 16, v118
  v_lshl_or_b32 v150, v121, 16, v120
  v_lshl_or_b32 v151, v123, 16, v122
  v_lshl_or_b32 v152, v125, 16, v124
concat_heads__linear_kernel_hedgehog__softmax_full_mha__prompt_kernel_gbr:
  v_mov_b32 v16, 0
  v_mov_b32 v17, 0
  v_mov_b32 v18, 0
  v_mov_b32 v19, 0
  v_mov_b32 v20, 0
  v_mov_b32 v21, 0
  v_mov_b32 v22, 0
  v_mov_b32 v23, 0
  v_mov_b32 v24, 0
  v_mov_b32 v25, 0
  v_mov_b32 v26, 0
  v_mov_b32 v27, 0
  v_mov_b32 v28, 0
  v_mov_b32 v29, 0
  v_mov_b32 v30, 0
  v_mov_b32 v31, 0
  v_mov_b32 v32, 0
  v_mov_b32 v33, 0
  v_mov_b32 v34, 0
  v_mov_b32 v35, 0
  v_mov_b32 v36, 0
  v_mov_b32 v37, 0
  v_mov_b32 v38, 0
  v_mov_b32 v39, 0
  v_mov_b32 v40, 0
  v_mov_b32 v41, 0
  v_mov_b32 v42, 0
  v_mov_b32 v43, 0
  v_mov_b32 v44, 0
  v_mov_b32 v45, 0
  v_mov_b32 v46, 0
  v_mov_b32 v47, 0
  v_mov_b32 v48, 0
  v_mov_b32 v49, 0
  v_mov_b32 v50, 0
  v_mov_b32 v51, 0
  v_mov_b32 v52, 0
  v_mov_b32 v53, 0
  v_mov_b32 v54, 0
  v_mov_b32 v55, 0
  v_mov_b32 v56, 0
  v_mov_b32 v57, 0
  v_mov_b32 v58, 0
  v_mov_b32 v59, 0
  v_mov_b32 v60, 0
  v_mov_b32 v61, 0
  v_mov_b32 v62, 0
  v_mov_b32 v63, 0
  v_mov_b32 v64, 0
  v_mov_b32 v65, 0
  v_mov_b32 v66, 0
  v_mov_b32 v67, 0
  v_mov_b32 v68, 0
  v_mov_b32 v69, 0
  v_mov_b32 v70, 0
  v_mov_b32 v71, 0
  v_mov_b32 v72, 0
  v_mov_b32 v73, 0
  v_mov_b32 v74, 0
  v_mov_b32 v75, 0
  v_mov_b32 v76, 0
  v_mov_b32 v77, 0
  v_mov_b32 v78, 0
  v_mov_b32 v79, 0
  s_mov_b32 s61, 1048576
  s_waitcnt lgkmcnt(0)
concat_heads__linear_kernel_hedgehog__softmax_full_mha__prompt_kernel_c0:
  ds_read_b32 v144, v145
  s_sub_u32 s61, s61, 1
  s_waitcnt lgkmcnt(0)
  s_cbranch_scc1 concat_heads__linear_kernel_hedgehog__softmax_full_mha__prompt_kernel_c0k
  v_cmp_ne_u32 vcc, 0, v144
  s_cbranch_vccnz concat_heads__linear_kernel_hedgehog__softmax_full_mha__prompt_kernel_c0
concat_heads__linear_kernel_hedgehog__softmax_full_mha__prompt_kernel_c0k:
  ds_read_b128 v[80:83], v2
  ds_read_b64_tr_b16 v[112:113], v6 offset:0
  ds_read_b64_tr_b16 v[114:115], v6 offset:1024
  ds_read_b128 v[84:87], v2 offset:4096
  ds_read_b64_tr_b16 v[116:117], v7 offset:0
  ds_read_b64_tr_b16 v[118:119], v7 offset:1024
  ds_read_b128 v[88:91], v3
  ds_read_b64_tr_b16 v[120:121], v6 offset:4096
  ds_read_b64_tr_b16 v[122:123], v6 offset:5120
  ds_read_b128 v[92:95], v3 offset:4096
  ds_read_b64_tr_b16 v[124:125], v7 offset:4096
  ds_read_b64_tr_b16 v[126:127], v7 offset:5120
  s_cmp_ge_u32 s31, 9
  s_cbranch_scc1 concat_heads__linear_kernel_hedgehog__softmax_full_mha__prompt_kernel_v2
concat_heads__linear_kernel_hedgehog__softmax_full_mha__prompt_kernel_v1:
  s_waitcnt lgkmcnt(6)
  v_mfma_f32_32x32x16_bf16 v[16:31], v[112:115], v[80:83], v[16:31]
  ds_read_b128 v[96:99], v4
  ds_read_b64_tr_b16 v[128:129], v6 offset:8192
  ds_read_b64_tr_b16 v[130:131], v6 offset:9216
  v_mfma_f32_32x32x16_bf16 v[32:47], v[112:115], v[84:87], v[32:47]
  ds_read_b128 v[100:103], v4 offset:4096
  ds_read_b64_tr_b16 v[132:133], v7 offset:8192
  ds_read_b64_tr_b16 v[134:135], v7 offset:9216
  v_mfma_f32_32x32x16_bf16 v[48:63], v[116:119], v[80:83], v[48:63]
  s_add_u32 s67, s67, 1
  s_cmp_eq_u32 s67, 4
  s_cselect_b32 s3, s27, s35
  s_cselect_b32 s67, 0, s67
  v_mfma_f32_32x32x16_bf16 v[64:79], v[116:119], v[84:87], v[64:79]
  s_waitcnt lgkmcnt(6)
  v_mfma_f32_32x32x16_bf16 v[16:31], v[120:123], v[88:91], v[16:31]
  ds_read_b32 v144, v145 offset:16
  ds_read_b128 v[104:107], v5
  ds_read_b64_tr_b16 v[136:137], v6 offset:12288
  ds_read_b64_tr_b16 v[138:139], v6 offset:13312
  v_mfma_f32_32x32x16_bf16 v[32:47], v[120:123], v[92:95], v[32:47]
  ds_read_b128 v[108:111], v5 offset:4096
  ds_read_b64_tr_b16 v[140:141], v7 offset:12288
  ds_read_b64_tr_b16 v[142:143], v7 offset:13312
  v_mfma_f32_32x32x16_bf16 v[48:63], v[124:127], v[88:91], v[48:63]
  v_add_u32 v2, s3, v2
  v_add_u32 v3, s3, v3
  v_add_u32 v6, s3, v6
  v_add_u32 v7, s3, v7
  v_mfma_f32_32x32x16_bf16 v[64:79], v[124:127], v[92:95], v[64:79]
  s_waitcnt lgkmcnt(6)
  v_mfma_f32_32x32x16_bf16 v[16:31], v[128:131], v[96:99], v[16:31]
  v_cmp_ne_u32 vcc, 0, v144
  s_cbranch_vccnz concat_heads__linear_kernel_hedgehog__softmax_full_mha__prompt_kernel_sp1
concat_heads__linear_kernel_hedgehog__softmax_full_mha__prompt_kernel_sr1:
  v_mfma_f32_32x32x16_bf16 v[32:47], v[128:131], v[100:103], v[32:47]
  ds_read_b128 v[80:83], v2
  ds_read_b64_tr_b16 v[112:113], v6 offset:0
  ds_read_b64_tr_b16 v[114:115], v6 offset:1024
  v_mfma_f32_32x32x16_bf16 v[48:63], v[132:135], v[96:99], v[48:63]
  ds_read_b128 v[84:87], v2 offset:4096
  ds_read_b64_tr_b16 v[116:117], v7 offset:0
  ds_read_b64_tr_b16 v[118:119], v7 offset:1024
  v_add_u32 v4, s3, v4
  v_add_u32 v5, s3, v5
  v_mfma_f32_32x32x16_bf16 v[64:79], v[132:135], v[100:103], v[64:79]
  s_waitcnt lgkmcnt(6)
  v_mfma_f32_32x32x16_bf16 v[16:31], v[136:139], v[104:107], v[16:31]
  ds_read_b128 v[88:91], v3
  ds_read_b64_tr_b16 v[120:121], v6 offset:4096
  ds_read_b64_tr_b16 v[122:123], v6 offset:5120
  v_mfma_f32_32x32x16_bf16 v[32:47], v[136:139], v[108:111], v[32:47]
  ds_read_b128 v[92:95], v3 offset:4096
  ds_read_b64_tr_b16 v[124:125], v7 offset:4096
  ds_read_b64_tr_b16 v[126:127], v7 offset:5120
  s_mov_b32 m0, s101
  v_add_u32 v145, 16, v145
  v_mfma_f32_32x32x16_bf16 v[48:63], v[140:143], v[104:107], v[48:63]
  s_cmp_eq_u32 s66, 9
  s_cbranch_scc1 concat_heads__linear_kernel_hedgehog__softmax_full_mha__prompt_kernel_hook
concat_heads__linear_kernel_hedgehog__softmax_full_mha__prompt_kernel_hr1:
  s_mov_b64 exec, 1
  buffer_load_dword v0, s[12:15], 0 offen lds
  s_mov_b64 exec, -1
concat_heads__linear_kernel_hedgehog__softmax_full_mha__prompt_kernel_nf1:
  s_add_u32 s101, s101, 16
  s_add_u32 s66, s66, 1
  s_bitcmp1_b32 262656, s66
  v_mfma_f32_32x32x16_bf16 v[64:79], v[140:143], v[108:111], v[64:79]
  s_cbranch_scc0 concat_heads__linear_kernel_hedgehog__softmax_full_mha__prompt_kernel_v1
  v_mov_b32 v13, 0
  s_mul_i32 s61, s34, 8388608
  s_cmp_eq_u32 s34, 0
  s_cbranch_scc1 concat_heads__linear_kernel_hedgehog__softmax_full_mha__prompt_kernel_nq1
  s_branch concat_heads__linear_kernel_hedgehog__softmax_full_mha__prompt_kernel_nh1
concat_heads__linear_kernel_hedgehog__softmax_full_mha__prompt_kernel_nq1:
  v_and_b32 v2, 3, v0
  v_lshlrev_b32 v2, 2, v2
  v_add_u32 v2, 161408, v2
  s_mov_b32 s61, 1048576
concat_heads__linear_kernel_hedgehog__softmax_full_mha__prompt_kernel_gb_7:
  ds_read_b32 v3, v2
  s_sub_u32 s61, s61, 1
  s_waitcnt lgkmcnt(0)
  s_cbranch_scc1 concat_heads__linear_kernel_hedgehog__softmax_full_mha__prompt_kernel_gb_7x
  v_cmp_ne_u32 vcc, 0, v3
  s_cbranch_vccz concat_heads__linear_kernel_hedgehog__softmax_full_mha__prompt_kernel_gb_7x
  s_sleep 2
  s_branch concat_heads__linear_kernel_hedgehog__softmax_full_mha__prompt_kernel_gb_7
concat_heads__linear_kernel_hedgehog__softmax_full_mha__prompt_kernel_gb_7x:
  s_mov_b32 s61, 0
  s_cmp_eq_u32 s34, 0
concat_heads__linear_kernel_hedgehog__softmax_full_mha__prompt_kernel_nh1:
  s_nop 7
  s_cmp_lt_u32 s62, 32
  s_cselect_b32 s56, s34, 0
  s_lshl_b32 s58, s62, 6
  s_add_u32 s58, s58, s98
  s_lshl_b32 s58, s58, 10
  s_add_u32 s58, s58, s61
  s_cmp_eq_u32 s56, 0
  s_cbranch_scc1 concat_heads__linear_kernel_hedgehog__softmax_full_mha__prompt_kernel_ns_8
  v_mul_f32 v16, s100, v16
  v_mul_f32 v17, s100, v17
  v_mul_f32 v18, s100, v18
  v_mul_f32 v19, s100, v19
  v_mul_f32 v20, s100, v20
  v_mul_f32 v21, s100, v21
  v_mul_f32 v22, s100, v22
  v_mul_f32 v23, s100, v23
  v_mul_f32 v32, s100, v32
  v_mul_f32 v33, s100, v33
  v_mul_f32 v34, s100, v34
  v_mul_f32 v35, s100, v35
  v_mul_f32 v36, s100, v36
  v_mul_f32 v37, s100, v37
  v_mul_f32 v38, s100, v38
  v_mul_f32 v39, s100, v39
concat_heads__linear_kernel_hedgehog__softmax_full_mha__prompt_kernel_ns_8:
  v_cvt_pk_bf16_f32 v96, v16, v17
  v_cvt_pk_bf16_f32 v97, v18, v19
  v_cvt_pk_bf16_f32 v98, v20, v21
  v_cvt_pk_bf16_f32 v99, v22, v23
  buffer_store_dwordx2 v[96:97], v11, s[4:7], s58 offen offset:0 sc1
  buffer_store_dwordx2 v[98:99], v11, s[4:7], s58 offen offset:512 sc1
  v_cvt_pk_bf16_f32 v100, v32, v33
  v_cvt_pk_bf16_f32 v101, v34, v35
  v_cvt_pk_bf16_f32 v102, v36, v37
  v_cvt_pk_bf16_f32 v103, v38, v39
  buffer_store_dwordx2 v[100:101], v11, s[4:7], s58 offen offset:1024 sc1
  buffer_store_dwordx2 v[102:103], v11, s[4:7], s58 offen offset:1536 sc1
  s_cmp_lt_u32 s64, 32
  s_cselect_b32 s56, s34, 0
  s_lshl_b32 s58, s64, 6
  s_add_u32 s58, s58, s98
  s_lshl_b32 s58, s58, 10
  s_add_u32 s58, s58, s61
  s_cmp_eq_u32 s56, 0
  s_cbranch_scc1 concat_heads__linear_kernel_hedgehog__softmax_full_mha__prompt_kernel_ns_9
  v_mul_f32 v24, s100, v24
  v_mul_f32 v25, s100, v25
  v_mul_f32 v26, s100, v26
  v_mul_f32 v27, s100, v27
  v_mul_f32 v28, s100, v28
  v_mul_f32 v29, s100, v29
  v_mul_f32 v30, s100, v30
  v_mul_f32 v31, s100, v31
  v_mul_f32 v40, s100, v40
  v_mul_f32 v41, s100, v41
  v_mul_f32 v42, s100, v42
  v_mul_f32 v43, s100, v43
  v_mul_f32 v44, s100, v44
  v_mul_f32 v45, s100, v45
  v_mul_f32 v46, s100, v46
  v_mul_f32 v47, s100, v47
concat_heads__linear_kernel_hedgehog__softmax_full_mha__prompt_kernel_ns_9:
  v_cvt_pk_bf16_f32 v104, v24, v25
  v_cvt_pk_bf16_f32 v105, v26, v27
  v_cvt_pk_bf16_f32 v106, v28, v29
  v_cvt_pk_bf16_f32 v107, v30, v31
  buffer_store_dwordx2 v[104:105], v11, s[4:7], s58 offen offset:0 sc1
  buffer_store_dwordx2 v[106:107], v11, s[4:7], s58 offen offset:512 sc1
  v_cvt_pk_bf16_f32 v108, v40, v41
  v_cvt_pk_bf16_f32 v109, v42, v43
  v_cvt_pk_bf16_f32 v110, v44, v45
  v_cvt_pk_bf16_f32 v111, v46, v47
  buffer_store_dwordx2 v[108:109], v11, s[4:7], s58 offen offset:1024 sc1
  buffer_store_dwordx2 v[110:111], v11, s[4:7], s58 offen offset:1536 sc1
  s_cmp_eq_u32 s69, 0
  s_cbranch_scc0 concat_heads__linear_kernel_hedgehog__softmax_full_mha__prompt_kernel_erem
  s_cmp_lt_u32 s63, 32
  s_cselect_b32 s56, s34, 0
  s_lshl_b32 s58, s63, 6
  s_add_u32 s58, s58, s98
  s_lshl_b32 s58, s58, 10
  s_add_u32 s58, s58, s61
  s_cmp_eq_u32 s56, 0
  s_cbranch_scc1 concat_heads__linear_kernel_hedgehog__softmax_full_mha__prompt_kernel_ns_10
  v_mul_f32 v48, s100, v48
  v_mul_f32 v49, s100, v49
  v_mul_f32 v50, s100, v50
  v_mul_f32 v51, s100, v51
  v_mul_f32 v52, s100, v52
  v_mul_f32 v53, s100, v53
  v_mul_f32 v54, s100, v54
  v_mul_f32 v55, s100, v55
  v_mul_f32 v64, s100, v64
  v_mul_f32 v65, s100, v65
  v_mul_f32 v66, s100, v66
  v_mul_f32 v67, s100, v67
  v_mul_f32 v68, s100, v68
  v_mul_f32 v69, s100, v69
  v_mul_f32 v70, s100, v70
  v_mul_f32 v71, s100, v71
concat_heads__linear_kernel_hedgehog__softmax_full_mha__prompt_kernel_ns_10:
  v_cvt_pk_bf16_f32 v96, v48, v49
  v_cvt_pk_bf16_f32 v97, v50, v51
  v_cvt_pk_bf16_f32 v98, v52, v53
  v_cvt_pk_bf16_f32 v99, v54, v55
  buffer_store_dwordx2 v[96:97], v11, s[4:7], s58 offen offset:0 sc1
  buffer_store_dwordx2 v[98:99], v11, s[4:7], s58 offen offset:512 sc1
  v_cvt_pk_bf16_f32 v100, v64, v65
  v_cvt_pk_bf16_f32 v101, v66, v67
  v_cvt_pk_bf16_f32 v102, v68, v69
  v_cvt_pk_bf16_f32 v103, v70, v71
  buffer_store_dwordx2 v[100:101], v11, s[4:7], s58 offen offset:1024 sc1
  buffer_store_dwordx2 v[102:103], v11, s[4:7], s58 offen offset:1536 sc1
  s_cmp_lt_u32 s65, 32
  s_cselect_b32 s56, s34, 0
  s_lshl_b32 s58, s65, 6
  s_add_u32 s58, s58, s98
  s_lshl_b32 s58, s58, 10
  s_add_u32 s58, s58, s61
  s_cmp_eq_u32 s56, 0
  s_cbranch_scc1 concat_heads__linear_kernel_hedgehog__softmax_full_mha__prompt_kernel_ns_11
  v_mul_f32 v56, s100, v56
  v_mul_f32 v57, s100, v57
  v_mul_f32 v58, s100, v58
  v_mul_f32 v59, s100, v59
  v_mul_f32 v60, s100, v60
  v_mul_f32 v61, s100, v61
  v_mul_f32 v62, s100, v62
  v_mul_f32 v63, s100, v63
  v_mul_f32 v72, s100, v72
  v_mul_f32 v73, s100, v73
  v_mul_f32 v74, s100, v74
  v_mul_f32 v75, s100, v75
  v_mul_f32 v76, s100, v76
  v_mul_f32 v77, s100, v77
  v_mul_f32 v78, s100, v78
  v_mul_f32 v79, s100, v79
concat_heads__linear_kernel_hedgehog__softmax_full_mha__prompt_kernel_ns_11:
  v_cvt_pk_bf16_f32 v104, v56, v57
  v_cvt_pk_bf16_f32 v105, v58, v59
  v_cvt_pk_bf16_f32 v106, v60, v61
  v_cvt_pk_bf16_f32 v107, v62, v63
  buffer_store_dwordx2 v[104:105], v11, s[4:7], s58 offen offset:0 sc1
  buffer_store_dwordx2 v[106:107], v11, s[4:7], s58 offen offset:512 sc1
  v_cvt_pk_bf16_f32 v108, v72, v73
  v_cvt_pk_bf16_f32 v109, v74, v75
  v_cvt_pk_bf16_f32 v110, v76, v77
  v_cvt_pk_bf16_f32 v111, v78, v79
  buffer_store_dwordx2 v[108:109], v11, s[4:7], s58 offen offset:1024 sc1
  buffer_store_dwordx2 v[110:111], v11, s[4:7], s58 offen offset:1536 sc1
  s_branch concat_heads__linear_kernel_hedgehog__softmax_full_mha__prompt_kernel_edone
concat_heads__linear_kernel_hedgehog__softmax_full_mha__prompt_kernel_sp1:
  s_bitcmp1_b32 131328, s66
  s_cbranch_scc1 concat_heads__linear_kernel_hedgehog__softmax_full_mha__prompt_kernel_sr1
  s_mov_b32 s61, 1048576
concat_heads__linear_kernel_hedgehog__softmax_full_mha__prompt_kernel_sq1:
  ds_read_b32 v144, v145 offset:16
  s_sub_u32 s61, s61, 1
  s_waitcnt lgkmcnt(0)
  s_cbranch_scc1 concat_heads__linear_kernel_hedgehog__softmax_full_mha__prompt_kernel_sr1
  v_cmp_ne_u32 vcc, 0, v144
  s_cbranch_vccnz concat_heads__linear_kernel_hedgehog__softmax_full_mha__prompt_kernel_sq1
  s_branch concat_heads__linear_kernel_hedgehog__softmax_full_mha__prompt_kernel_sr1
concat_heads__linear_kernel_hedgehog__softmax_full_mha__prompt_kernel_v2:
  s_waitcnt lgkmcnt(6)
  v_mfma_f32_32x32x16_bf16 v[16:31], v[80:83], v[112:115], v[16:31]
  ds_read_b128 v[96:99], v4
  ds_read_b64_tr_b16 v[128:129], v6 offset:8192
  ds_read_b64_tr_b16 v[130:131], v6 offset:9216
  v_mfma_f32_32x32x16_bf16 v[32:47], v[84:87], v[112:115], v[32:47]
  ds_read_b128 v[100:103], v4 offset:4096
  ds_read_b64_tr_b16 v[132:133], v7 offset:8192
  ds_read_b64_tr_b16 v[134:135], v7 offset:9216
  v_mfma_f32_32x32x16_bf16 v[48:63], v[80:83], v[116:119], v[48:63]
  s_add_u32 s67, s67, 1
  s_cmp_eq_u32 s67, 4
  s_cselect_b32 s3, s27, s35
  s_cselect_b32 s67, 0, s67
  v_mfma_f32_32x32x16_bf16 v[64:79], v[84:87], v[116:119], v[64:79]
  s_waitcnt lgkmcnt(6)
  v_mfma_f32_32x32x16_bf16 v[16:31], v[88:91], v[120:123], v[16:31]
  ds_read_b32 v144, v145 offset:16
  ds_read_b128 v[104:107], v5
  ds_read_b64_tr_b16 v[136:137], v6 offset:12288
  ds_read_b64_tr_b16 v[138:139], v6 offset:13312
  v_mfma_f32_32x32x16_bf16 v[32:47], v[92:95], v[120:123], v[32:47]
  ds_read_b128 v[108:111], v5 offset:4096
  ds_read_b64_tr_b16 v[140:141], v7 offset:12288
  ds_read_b64_tr_b16 v[142:143], v7 offset:13312
  v_mfma_f32_32x32x16_bf16 v[48:63], v[88:91], v[124:127], v[48:63]
  v_add_u32 v2, s3, v2
  v_add_u32 v3, s3, v3
  v_add_u32 v6, s3, v6
  v_add_u32 v7, s3, v7
  v_mfma_f32_32x32x16_bf16 v[64:79], v[92:95], v[124:127], v[64:79]
  s_waitcnt lgkmcnt(6)
  v_mfma_f32_32x32x16_bf16 v[16:31], v[96:99], v[128:131], v[16:31]
  v_cmp_ne_u32 vcc, 0, v144
  s_cbranch_vccnz concat_heads__linear_kernel_hedgehog__softmax_full_mha__prompt_kernel_sp2
concat_heads__linear_kernel_hedgehog__softmax_full_mha__prompt_kernel_sr2:
  v_mfma_f32_32x32x16_bf16 v[32:47], v[100:103], v[128:131], v[32:47]
  ds_read_b128 v[80:83], v2
  ds_read_b64_tr_b16 v[112:113], v6 offset:0
  ds_read_b64_tr_b16 v[114:115], v6 offset:1024
  v_mfma_f32_32x32x16_bf16 v[48:63], v[96:99], v[132:135], v[48:63]
  ds_read_b128 v[84:87], v2 offset:4096
  ds_read_b64_tr_b16 v[116:117], v7 offset:0
  ds_read_b64_tr_b16 v[118:119], v7 offset:1024
  v_add_u32 v4, s3, v4
  v_add_u32 v5, s3, v5
  v_mfma_f32_32x32x16_bf16 v[64:79], v[100:103], v[132:135], v[64:79]
  s_waitcnt lgkmcnt(6)
  v_mfma_f32_32x32x16_bf16 v[16:31], v[104:107], v[136:139], v[16:31]
  ds_read_b128 v[88:91], v3
  ds_read_b64_tr_b16 v[120:121], v6 offset:4096
  ds_read_b64_tr_b16 v[122:123], v6 offset:5120
  v_mfma_f32_32x32x16_bf16 v[32:47], v[108:111], v[136:139], v[32:47]
  ds_read_b128 v[92:95], v3 offset:4096
  ds_read_b64_tr_b16 v[124:125], v7 offset:4096
  ds_read_b64_tr_b16 v[126:127], v7 offset:5120
  s_mov_b32 m0, s101
  v_add_u32 v145, 16, v145
  v_mfma_f32_32x32x16_bf16 v[48:63], v[104:107], v[140:143], v[48:63]
  s_cmp_eq_u32 s66, 9
  s_cbranch_scc1 concat_heads__linear_kernel_hedgehog__softmax_full_mha__prompt_kernel_hook
concat_heads__linear_kernel_hedgehog__softmax_full_mha__prompt_kernel_hr2:
  s_mov_b64 exec, 1
  buffer_load_dword v0, s[12:15], 0 offen lds
  s_mov_b64 exec, -1
concat_heads__linear_kernel_hedgehog__softmax_full_mha__prompt_kernel_nf2:
  s_add_u32 s101, s101, 16
  s_add_u32 s66, s66, 1
  s_bitcmp1_b32 262656, s66
  v_mfma_f32_32x32x16_bf16 v[64:79], v[108:111], v[140:143], v[64:79]
  s_cbranch_scc0 concat_heads__linear_kernel_hedgehog__softmax_full_mha__prompt_kernel_v2
  v_mov_b32 v13, 0
  s_mul_i32 s61, s34, 8388608
  s_cmp_eq_u32 s34, 0
  s_cbranch_scc1 concat_heads__linear_kernel_hedgehog__softmax_full_mha__prompt_kernel_nq2
  s_branch concat_heads__linear_kernel_hedgehog__softmax_full_mha__prompt_kernel_nh2
concat_heads__linear_kernel_hedgehog__softmax_full_mha__prompt_kernel_nq2:
  v_and_b32 v2, 3, v0
  v_lshlrev_b32 v2, 2, v2
  v_add_u32 v2, 161408, v2
  s_mov_b32 s61, 1048576
concat_heads__linear_kernel_hedgehog__softmax_full_mha__prompt_kernel_gb_12:
  ds_read_b32 v3, v2
  s_sub_u32 s61, s61, 1
  s_waitcnt lgkmcnt(0)
  s_cbranch_scc1 concat_heads__linear_kernel_hedgehog__softmax_full_mha__prompt_kernel_gb_12x
  v_cmp_ne_u32 vcc, 0, v3
  s_cbranch_vccz concat_heads__linear_kernel_hedgehog__softmax_full_mha__prompt_kernel_gb_12x
  s_sleep 2
  s_branch concat_heads__linear_kernel_hedgehog__softmax_full_mha__prompt_kernel_gb_12
concat_heads__linear_kernel_hedgehog__softmax_full_mha__prompt_kernel_gb_12x:
  s_mov_b32 s61, 0
  s_cmp_eq_u32 s34, 0
concat_heads__linear_kernel_hedgehog__softmax_full_mha__prompt_kernel_nh2:
  s_nop 7
  s_lshl_b32 s56, s31, 1
  s_add_u32 s56, s56, s69
  s_cmp_eq_u32 s56, 27
  s_cbranch_scc1 concat_heads__linear_kernel_hedgehog__softmax_full_mha__prompt_kernel_edone
  s_lshl_b32 s56, s31, 1
  s_add_u32 s56, s56, s69
  s_lshl_b32 s56, s56, 6
  s_add_u32 s56, s56, 4294966144
  v_add_u32 v13, s56, v9
  v_mul_u32_u24 v14, 3641, v13
  v_lshrrev_b32 v14, 16, v14
  v_mul_u32_u24 v15, 18, v14
  v_sub_u32 v13, v13, v15
  v_and_b32 v15, 1, v14
  v_lshrrev_b32 v14, 1, v14
  v_mul_u32_u24 v14, 147456, v14
  v_lshlrev_b32 v128, 1, v15
  v_sub_u32 v128, v13, v128
  v_cmp_gt_u32 vcc, 16, v128
  v_lshlrev_b32 v128, 4, v128
  v_lshl_add_u32 v128, v15, 10, v128
  v_lshl_add_u32 v128, v8, 8, v128
  v_and_b32 v13, 1, v13
  v_lshl_add_u32 v13, v15, 1, v13
  v_lshl_add_u32 v13, v8, 2, v13
  v_lshlrev_b32 v13, 4, v13
  v_add_u32 v13, 2048, v13
  v_cndmask_b32 v13, v13, v128, vcc
  v_mov_b32 v15, 128
  v_mov_b32 v128, 512
  v_add_u32 v13, v13, v14
  v_cndmask_b32 v15, v15, v128, vcc
  s_mul_i32 s58, s98, 2304
  s_add_u32 s58, s58, s61
  s_add_u32 s58, s58, 4194304
  v_add_u32 v15, v15, v13
  v_cvt_pk_bf16_f32 v96, v16, v17
  v_cvt_pk_bf16_f32 v97, v18, v19
  v_cvt_pk_bf16_f32 v98, v20, v21
  v_cvt_pk_bf16_f32 v99, v22, v23
  buffer_store_dwordx4 v[96:99], v13, s[4:7], s58 offen offset:0 sc1
  v_cvt_pk_bf16_f32 v100, v24, v25
  v_cvt_pk_bf16_f32 v101, v26, v27
  v_cvt_pk_bf16_f32 v102, v28, v29
  v_cvt_pk_bf16_f32 v103, v30, v31
  buffer_store_dwordx4 v[100:103], v15, s[4:7], s58 offen offset:0 sc1
  v_cvt_pk_bf16_f32 v104, v32, v33
  v_cvt_pk_bf16_f32 v105, v34, v35
  v_cvt_pk_bf16_f32 v106, v36, v37
  v_cvt_pk_bf16_f32 v107, v38, v39
  buffer_store_dwordx4 v[104:107], v13, s[4:7], s58 offen offset:2304 sc1
  v_cvt_pk_bf16_f32 v108, v40, v41
  v_cvt_pk_bf16_f32 v109, v42, v43
  v_cvt_pk_bf16_f32 v110, v44, v45
  v_cvt_pk_bf16_f32 v111, v46, v47
  buffer_store_dwordx4 v[108:111], v15, s[4:7], s58 offen offset:2304 sc1
  s_lshl_b32 s56, s31, 1
  s_add_u32 s56, s56, s69
  s_lshl_b32 s56, s56, 6
  s_add_u32 s56, s56, 4294966176
  v_add_u32 v13, s56, v9
  v_mul_u32_u24 v14, 3641, v13
  v_lshrrev_b32 v14, 16, v14
  v_mul_u32_u24 v15, 18, v14
  v_sub_u32 v13, v13, v15
  v_and_b32 v15, 1, v14
  v_lshrrev_b32 v14, 1, v14
  v_mul_u32_u24 v14, 147456, v14
  v_lshlrev_b32 v128, 1, v15
  v_sub_u32 v128, v13, v128
  v_cmp_gt_u32 vcc, 16, v128
  v_lshlrev_b32 v128, 4, v128
  v_lshl_add_u32 v128, v15, 10, v128
  v_lshl_add_u32 v128, v8, 8, v128
  v_and_b32 v13, 1, v13
  v_lshl_add_u32 v13, v15, 1, v13
  v_lshl_add_u32 v13, v8, 2, v13
  v_lshlrev_b32 v13, 4, v13
  v_add_u32 v13, 2048, v13
  v_cndmask_b32 v13, v13, v128, vcc
  v_mov_b32 v15, 128
  v_mov_b32 v128, 512
  v_add_u32 v13, v13, v14
  v_cndmask_b32 v15, v15, v128, vcc
  s_mul_i32 s58, s98, 2304
  s_add_u32 s58, s58, s61
  s_add_u32 s58, s58, 4194304
  v_add_u32 v15, v15, v13
  v_cvt_pk_bf16_f32 v96, v48, v49
  v_cvt_pk_bf16_f32 v97, v50, v51
  v_cvt_pk_bf16_f32 v98, v52, v53
  v_cvt_pk_bf16_f32 v99, v54, v55
  buffer_store_dwordx4 v[96:99], v13, s[4:7], s58 offen offset:0 sc1
  v_cvt_pk_bf16_f32 v100, v56, v57
  v_cvt_pk_bf16_f32 v101, v58, v59
  v_cvt_pk_bf16_f32 v102, v60, v61
  v_cvt_pk_bf16_f32 v103, v62, v63
  buffer_store_dwordx4 v[100:103], v15, s[4:7], s58 offen offset:0 sc1
  v_cvt_pk_bf16_f32 v104, v64, v65
  v_cvt_pk_bf16_f32 v105, v66, v67
  v_cvt_pk_bf16_f32 v106, v68, v69
  v_cvt_pk_bf16_f32 v107, v70, v71
  buffer_store_dwordx4 v[104:107], v13, s[4:7], s58 offen offset:2304 sc1
  v_cvt_pk_bf16_f32 v108, v72, v73
  v_cvt_pk_bf16_f32 v109, v74, v75
  v_cvt_pk_bf16_f32 v110, v76, v77
  v_cvt_pk_bf16_f32 v111, v78, v79
  buffer_store_dwordx4 v[108:111], v15, s[4:7], s58 offen offset:2304 sc1
  s_branch concat_heads__linear_kernel_hedgehog__softmax_full_mha__prompt_kernel_edone
concat_heads__linear_kernel_hedgehog__softmax_full_mha__prompt_kernel_sp2:
  s_bitcmp1_b32 131328, s66
  s_cbranch_scc1 concat_heads__linear_kernel_hedgehog__softmax_full_mha__prompt_kernel_sr2
  s_mov_b32 s61, 1048576
concat_heads__linear_kernel_hedgehog__softmax_full_mha__prompt_kernel_sq2:
  ds_read_b32 v144, v145 offset:16
  s_sub_u32 s61, s61, 1
  s_waitcnt lgkmcnt(0)
  s_cbranch_scc1 concat_heads__linear_kernel_hedgehog__softmax_full_mha__prompt_kernel_sr2
  v_cmp_ne_u32 vcc, 0, v144
  s_cbranch_vccnz concat_heads__linear_kernel_hedgehog__softmax_full_mha__prompt_kernel_sq2
  s_branch concat_heads__linear_kernel_hedgehog__softmax_full_mha__prompt_kernel_sr2
concat_heads__linear_kernel_hedgehog__softmax_full_mha__prompt_kernel_hook:
  s_waitcnt vmcnt(0)
  s_add_u32 m0, s97, 161728
  s_mov_b64 exec, 1
  buffer_load_dword v0, s[12:15], 0 offen lds
  s_mov_b64 exec, -1
  s_mov_b32 m0, s101
concat_heads__linear_kernel_hedgehog__softmax_full_mha__prompt_kernel_hret:
  s_cmp_ge_u32 s31, 9
  s_cbranch_scc1 concat_heads__linear_kernel_hedgehog__softmax_full_mha__prompt_kernel_hr2
  s_branch concat_heads__linear_kernel_hedgehog__softmax_full_mha__prompt_kernel_hr1
concat_heads__linear_kernel_hedgehog__softmax_full_mha__prompt_kernel_erem:
  s_cmp_eq_u32 s34, 0
  s_cselect_b32 s60, 1.0, s100
  v_mov_b32 v13, 0
  v_mad_u32_u24 v13, v8, 5, v13
  v_bfe_u32 v13, s10, v13, 5
  s_lshl_b32 s56, s31, 5
  v_add_u32 v13, s56, v13
  v_mul_u32_u24 v14, 57, v13
  v_lshrrev_b32 v14, 9, v14
  v_mul_u32_u24 v15, 9, v14
  v_sub_u32 v13, v13, v15
  v_cmp_gt_u32 vcc, 16, v14
  v_mov_b32 v128, s60
  v_lshlrev_b32 v129, 6, v14
  v_cndmask_b32 v128, 1.0, v128, vcc
  v_add_u32 v129, s98, v129
  v_lshlrev_b32 v129, 5, v129
  v_add_u32 v129, v129, v12
  v_lshlrev_b32 v129, 3, v129
  v_add_u32 v129, 6815744, v129
  v_cmp_lt_u32 vcc, 4, v13
  v_add_u32 v15, -5, v13
  s_nop 0
  v_addc_co_u32 v14, s[94:95], v14, v14, vcc
  v_cndmask_b32 v15, v13, v15, vcc
  v_lshl_add_u32 v14, v14, 6, s98
  v_lshl_add_u32 v14, v14, 2, v15
  v_lshl_add_u32 v14, v14, 5, v12
  v_lshlrev_b32 v14, 3, v14
  v_cmp_eq_u32 vcc, 4, v13
  v_mov_b32 v15, 1024
  v_mov_b32 v130, 256
  v_cndmask_b32 v14, v14, v129, vcc
  v_cndmask_b32 v15, v15, v130, vcc
  v_add_u32 v15, v15, v14
  s_cmp_eq_u32 s34, 0
  s_cbranch_scc1 concat_heads__linear_kernel_hedgehog__softmax_full_mha__prompt_kernel_ls_13
  v_mul_f32 v48, v128, v48
  v_mul_f32 v49, v128, v49
  v_mul_f32 v50, v128, v50
  v_mul_f32 v51, v128, v51
  v_mul_f32 v64, v128, v64
  v_mul_f32 v65, v128, v65
  v_mul_f32 v66, v128, v66
  v_mul_f32 v67, v128, v67
concat_heads__linear_kernel_hedgehog__softmax_full_mha__prompt_kernel_ls_13:
  v_cvt_pk_bf16_f32 v96, v48, v49
  v_cvt_pk_bf16_f32 v97, v50, v51
  buffer_store_dwordx2 v[96:97], v14, s[4:7], s61 offen sc1
  v_cvt_pk_bf16_f32 v98, v64, v65
  v_cvt_pk_bf16_f32 v99, v66, v67
  buffer_store_dwordx2 v[98:99], v15, s[4:7], s61 offen sc1
  v_mov_b32 v13, 10
  v_mad_u32_u24 v13, v8, 5, v13
  v_bfe_u32 v13, s10, v13, 5
  s_lshl_b32 s56, s31, 5
  v_add_u32 v13, s56, v13
  v_mul_u32_u24 v14, 57, v13
  v_lshrrev_b32 v14, 9, v14
  v_mul_u32_u24 v15, 9, v14
  v_sub_u32 v13, v13, v15
  v_cmp_gt_u32 vcc, 16, v14
  v_mov_b32 v128, s60
  v_lshlrev_b32 v129, 6, v14
  v_cndmask_b32 v128, 1.0, v128, vcc
  v_add_u32 v129, s98, v129
  v_lshlrev_b32 v129, 5, v129
  v_add_u32 v129, v129, v12
  v_lshlrev_b32 v129, 3, v129
  v_add_u32 v129, 6815744, v129
  v_cmp_lt_u32 vcc, 4, v13
  v_add_u32 v15, -5, v13
  s_nop 0
  v_addc_co_u32 v14, s[94:95], v14, v14, vcc
  v_cndmask_b32 v15, v13, v15, vcc
  v_lshl_add_u32 v14, v14, 6, s98
  v_lshl_add_u32 v14, v14, 2, v15
  v_lshl_add_u32 v14, v14, 5, v12
  v_lshlrev_b32 v14, 3, v14
  v_cmp_eq_u32 vcc, 4, v13
  v_mov_b32 v15, 1024
  v_mov_b32 v130, 256
  v_cndmask_b32 v14, v14, v129, vcc
  v_cndmask_b32 v15, v15, v130, vcc
  v_add_u32 v15, v15, v14
  s_cmp_eq_u32 s34, 0
  s_cbranch_scc1 concat_heads__linear_kernel_hedgehog__softmax_full_mha__prompt_kernel_ls_14
  v_mul_f32 v52, v128, v52
  v_mul_f32 v53, v128, v53
  v_mul_f32 v54, v128, v54
  v_mul_f32 v55, v128, v55
  v_mul_f32 v68, v128, v68
  v_mul_f32 v69, v128, v69
  v_mul_f32 v70, v128, v70
  v_mul_f32 v71, v128, v71
concat_heads__linear_kernel_hedgehog__softmax_full_mha__prompt_kernel_ls_14:
  v_cvt_pk_bf16_f32 v100, v52, v53
  v_cvt_pk_bf16_f32 v101, v54, v55
  buffer_store_dwordx2 v[100:101], v14, s[4:7], s61 offen sc1
  v_cvt_pk_bf16_f32 v102, v68, v69
  v_cvt_pk_bf16_f32 v103, v70, v71
  buffer_store_dwordx2 v[102:103], v15, s[4:7], s61 offen sc1
  v_mov_b32 v13, 0
  v_mad_u32_u24 v13, v8, 5, v13
  v_bfe_u32 v13, s11, v13, 5
  s_lshl_b32 s56, s31, 5
  v_add_u32 v13, s56, v13
  v_mul_u32_u24 v14, 57, v13
  v_lshrrev_b32 v14, 9, v14
  v_mul_u32_u24 v15, 9, v14
  v_sub_u32 v13, v13, v15
  v_cmp_gt_u32 vcc, 16, v14
  v_mov_b32 v128, s60
  v_lshlrev_b32 v129, 6, v14
  v_cndmask_b32 v128, 1.0, v128, vcc
  v_add_u32 v129, s98, v129
  v_lshlrev_b32 v129, 5, v129
  v_add_u32 v129, v129, v12
  v_lshlrev_b32 v129, 3, v129
  v_add_u32 v129, 6815744, v129
  v_cmp_lt_u32 vcc, 4, v13
  v_add_u32 v15, -5, v13
  s_nop 0
  v_addc_co_u32 v14, s[94:95], v14, v14, vcc
  v_cndmask_b32 v15, v13, v15, vcc
  v_lshl_add_u32 v14, v14, 6, s98
  v_lshl_add_u32 v14, v14, 2, v15
  v_lshl_add_u32 v14, v14, 5, v12
  v_lshlrev_b32 v14, 3, v14
  v_cmp_eq_u32 vcc, 4, v13
  v_mov_b32 v15, 1024
  v_mov_b32 v130, 256
  v_cndmask_b32 v14, v14, v129, vcc
  v_cndmask_b32 v15, v15, v130, vcc
  v_add_u32 v15, v15, v14
  s_cmp_eq_u32 s34, 0
  s_cbranch_scc1 concat_heads__linear_kernel_hedgehog__softmax_full_mha__prompt_kernel_ls_15
  v_mul_f32 v56, v128, v56
  v_mul_f32 v57, v128, v57
  v_mul_f32 v58, v128, v58
  v_mul_f32 v59, v128, v59
  v_mul_f32 v72, v128, v72
  v_mul_f32 v73, v128, v73
  v_mul_f32 v74, v128, v74
  v_mul_f32 v75, v128, v75
concat_heads__linear_kernel_hedgehog__softmax_full_mha__prompt_kernel_ls_15:
  v_cvt_pk_bf16_f32 v104, v56, v57
  v_cvt_pk_bf16_f32 v105, v58, v59
  buffer_store_dwordx2 v[104:105], v14, s[4:7], s61 offen sc1
  v_cvt_pk_bf16_f32 v106, v72, v73
  v_cvt_pk_bf16_f32 v107, v74, v75
  buffer_store_dwordx2 v[106:107], v15, s[4:7], s61 offen sc1
  v_mov_b32 v13, 10
  v_mad_u32_u24 v13, v8, 5, v13
  v_bfe_u32 v13, s11, v13, 5
  s_lshl_b32 s56, s31, 5
  v_add_u32 v13, s56, v13
  v_mul_u32_u24 v14, 57, v13
  v_lshrrev_b32 v14, 9, v14
  v_mul_u32_u24 v15, 9, v14
  v_sub_u32 v13, v13, v15
  v_cmp_gt_u32 vcc, 16, v14
  v_mov_b32 v128, s60
  v_lshlrev_b32 v129, 6, v14
  v_cndmask_b32 v128, 1.0, v128, vcc
  v_add_u32 v129, s98, v129
  v_lshlrev_b32 v129, 5, v129
  v_add_u32 v129, v129, v12
  v_lshlrev_b32 v129, 3, v129
  v_add_u32 v129, 6815744, v129
  v_cmp_lt_u32 vcc, 4, v13
  v_add_u32 v15, -5, v13
  s_nop 0
  v_addc_co_u32 v14, s[94:95], v14, v14, vcc
  v_cndmask_b32 v15, v13, v15, vcc
  v_lshl_add_u32 v14, v14, 6, s98
  v_lshl_add_u32 v14, v14, 2, v15
  v_lshl_add_u32 v14, v14, 5, v12
  v_lshlrev_b32 v14, 3, v14
  v_cmp_eq_u32 vcc, 4, v13
  v_mov_b32 v15, 1024
  v_mov_b32 v130, 256
  v_cndmask_b32 v14, v14, v129, vcc
  v_cndmask_b32 v15, v15, v130, vcc
  v_add_u32 v15, v15, v14
  s_cmp_eq_u32 s34, 0
  s_cbranch_scc1 concat_heads__linear_kernel_hedgehog__softmax_full_mha__prompt_kernel_ls_16
  v_mul_f32 v60, v128, v60
  v_mul_f32 v61, v128, v61
  v_mul_f32 v62, v128, v62
  v_mul_f32 v63, v128, v63
  v_mul_f32 v76, v128, v76
  v_mul_f32 v77, v128, v77
  v_mul_f32 v78, v128, v78
  v_mul_f32 v79, v128, v79
concat_heads__linear_kernel_hedgehog__softmax_full_mha__prompt_kernel_ls_16:
  v_cvt_pk_bf16_f32 v108, v60, v61
  v_cvt_pk_bf16_f32 v109, v62, v63
  buffer_store_dwordx2 v[108:109], v14, s[4:7], s61 offen sc1
  v_cvt_pk_bf16_f32 v110, v76, v77
  v_cvt_pk_bf16_f32 v111, v78, v79
  buffer_store_dwordx2 v[110:111], v15, s[4:7], s61 offen sc1
concat_heads__linear_kernel_hedgehog__softmax_full_mha__prompt_kernel_edone:
  s_sub_u32 s34, s34, 1
  s_cbranch_scc1 concat_heads__linear_kernel_hedgehog__softmax_full_mha__prompt_kernel_gdone
  s_branch concat_heads__linear_kernel_hedgehog__softmax_full_mha__prompt_kernel_gbr
concat_heads__linear_kernel_hedgehog__softmax_full_mha__prompt_kernel_gdone:
  s_waitcnt lgkmcnt(0)
  v_readfirstlane_b32 s25, v157
  s_add_u32 s25, s25, 1
  s_xor_b32 s26, s25, 0x5bd1e995
  s_lshl_b32 s62, s32, 16
  s_add_u32 s62, s62, 10485760
  s_lshr_b32 s56, s32, 1
  s_mul_i32 s63, s56, 147456
  s_add_u32 s63, s63, 12582912
  s_lshl_b32 s66, s56, 14
  s_add_u32 s64, s66, 15466496
  s_and_b32 s56, s24, 3
  s_lshl_b32 s57, s56, 10
  s_min_u32 s58, s56, 2
  s_lshl_b32 s35, s58, 10
  s_add_u32 s67, s35, s64
  s_sub_u32 s67, s67, 1024
  s_add_u32 s35, s35, 35840
  s_cmp_eq_u32 s56, 0
  s_cselect_b32 s67, s63, s67
  s_movk_i32 s96, 256
  s_cselect_b32 s96, 2304, s96
  s_mov_b32 s58, 1
  s_mul_i32 s27, s58, 19456
  s_add_u32 s27, s27, s57
  s_mul_i32 s68, s58, 32768
  s_add_u32 s68, s68, s57
  s_add_u32 s68, s68, s62
  s_mul_i32 s69, s58, 73728
  s_add_u32 s69, s69, s63
  s_lshl_b32 s58, s33, 3
  s_lshl_b32 s56, s56, 1
  s_add_u32 s65, s58, s56
  s_lshl_b32 s56, s65, 8
  s_add_u32 s66, s66, s56
  s_add_u32 s66, s66, 15204352
  s_mul_i32 s3, s33, 144
  s_setprio 3
  s_mov_b32 s28, 0x3ffff
  s_mov_b32 s29, 0x3ffff
  v_cmp_eq_u32 vcc, 18, v9
  v_mov_b32 v10, 0x3f803f80
  v_lshlrev_b32 v11, 2, v0
  v_cndmask_b32 v10, 0, v10, vcc
  v_mov_b32 v2, 160768
  v_mov_b32 v3, 1
  s_mov_b64 exec, 1
  ds_add_u32 v2, v3
  s_mov_b64 exec, -1
  s_mov_b32 s61, 1048576
concat_heads__linear_kernel_hedgehog__softmax_full_mha__prompt_kernel_gb_17:
  ds_read_b32 v3, v2
  s_sub_u32 s61, s61, 1
  s_waitcnt lgkmcnt(0)
  s_cbranch_scc1 concat_heads__linear_kernel_hedgehog__softmax_full_mha__prompt_kernel_gb_17x
  v_cmp_gt_u32 vcc, 4, v3
  s_cbranch_vccz concat_heads__linear_kernel_hedgehog__softmax_full_mha__prompt_kernel_gb_17x
  s_branch concat_heads__linear_kernel_hedgehog__softmax_full_mha__prompt_kernel_gb_17
concat_heads__linear_kernel_hedgehog__softmax_full_mha__prompt_kernel_gb_17x:
  s_lshl_b32 s56, s30, 4
  s_add_u32 s56, s56, s31
  s_lshl_b32 s56, s56, 9
  s_add_u32 s56, s56, 27394048
  s_lshl_b32 s57, s24, 7
  s_add_u32 s56, s56, s57
  s_waitcnt vmcnt(0)
  v_mov_b32 v136, s25
  v_mov_b32 v137, s26
  v_mov_b32 v138, s25
  v_mov_b32 v139, s26
  s_mov_b64 exec, 0xff
  buffer_store_dwordx4 v[136:139], v1, s[4:7], s56 offen sc1
  s_mov_b64 exec, -1
  s_nop 0
  v_and_b32 v2, 7, v0
  v_lshlrev_b32 v2, 2, v2
  v_add_u32 v2, 161488, v2
  s_mov_b32 s61, 1048576
concat_heads__linear_kernel_hedgehog__softmax_full_mha__prompt_kernel_gb_18:
  ds_read_b32 v3, v2
  s_sub_u32 s61, s61, 1
  s_waitcnt lgkmcnt(0)
  s_cbranch_scc1 concat_heads__linear_kernel_hedgehog__softmax_full_mha__prompt_kernel_gb_18x
  v_cmp_ne_u32 vcc, 0, v3
  s_cbranch_vccz concat_heads__linear_kernel_hedgehog__softmax_full_mha__prompt_kernel_gb_18x
  s_sleep 2
  s_branch concat_heads__linear_kernel_hedgehog__softmax_full_mha__prompt_kernel_gb_18
concat_heads__linear_kernel_hedgehog__softmax_full_mha__prompt_kernel_gb_18x:
  s_add_u32 m0, s27, 19456
  s_add_u32 s56, s68, 4294942720
  buffer_load_dwordx4 v1, s[4:7], s56 offen sc1 lds
  s_add_u32 m0, s27, 38912
  s_add_u32 s56, s68, 8192
  buffer_load_dwordx4 v1, s[4:7], s56 offen sc1 lds
  s_add_u32 m0, s27, 23552
  s_add_u32 s56, s68, 4294946816
  buffer_load_dwordx4 v1, s[4:7], s56 offen sc1 lds
  s_add_u32 m0, s27, 43008
  s_add_u32 s56, s68, 12288
  buffer_load_dwordx4 v1, s[4:7], s56 offen sc1 lds
  s_add_u32 m0, s27, 27648
  s_add_u32 s56, s69, 4294912000
  buffer_load_dwordx4 v154, s[4:7], s56 offen sc1 lds
  s_add_u32 m0, s27, 47104
  s_add_u32 s56, s69, 18432
  buffer_load_dwordx4 v154, s[4:7], s56 offen sc1 lds
  s_add_u32 m0, s27, 31744
  s_add_u32 s56, s69, 4294912000
  buffer_load_dwordx4 v155, s[4:7], s56 offen sc1 lds
  s_add_u32 m0, s27, 51200
  s_add_u32 s56, s69, 18432
  buffer_load_dwordx4 v155, s[4:7], s56 offen sc1 lds
  s_add_u32 m0, s35, 19456
  s_mul_i32 s56, s96, 8
  s_add_u32 s56, s56, s67
  buffer_load_dwordx4 v156, s[4:7], s56 offen sc1 lds
  s_add_u32 m0, s35, 38912
  s_mul_i32 s56, s96, 40
  s_add_u32 s56, s56, s67
  buffer_load_dwordx4 v156, s[4:7], s56 offen sc1 lds
  s_add_u32 m0, s97, 161424
  s_mov_b64 exec, 1
  buffer_load_dword v0, s[12:15], 0 offen lds
  s_mov_b64 exec, -1
  v_lshlrev_b32 v15, 3, v0
  v_mov_b32 v28, v10
  v_mov_b32 v29, v10
  v_mov_b32 v30, v10
  v_mov_b32 v31, v10
  v_mov_b32 v32, v10
  v_mov_b32 v33, v10
  v_mov_b32 v34, v10
  v_mov_b32 v35, v10
  v_mov_b32 v21, 0
  v_mov_b32 v27, 0
  v_mov_b32 v48, v10
  v_mov_b32 v49, v10
  v_mov_b32 v50, v10
  v_mov_b32 v51, v10
  v_mov_b32 v52, v10
  v_mov_b32 v53, v10
  v_mov_b32 v54, v10
  v_mov_b32 v55, v10
  v_mov_b32 v41, 0
  v_mov_b32 v47, 0
  s_mov_b32 s8, s42
  s_mov_b32 s9, s43
  s_mov_b32 s10, 663552
  s_mov_b32 s11, 0x20000
  buffer_load_dwordx2 v[138:139], v166, s[4:7], 0 offen sc1
  s_waitcnt vmcnt(0)
  s_mov_b32 s61, 1048576
concat_heads__linear_kernel_hedgehog__softmax_full_mha__prompt_kernel_plp_20:
  v_cmp_eq_u32 vcc, s25, v138
  v_cmp_eq_u32 s[94:95], s26, v139
  s_and_b64 vcc, vcc, s[94:95]
  s_cmp_eq_u64 vcc, -1
  s_cbranch_scc1 concat_heads__linear_kernel_hedgehog__softmax_full_mha__prompt_kernel_pok_19
  s_sub_u32 s61, s61, 1
  s_cbranch_scc1 concat_heads__linear_kernel_hedgehog__softmax_full_mha__prompt_kernel_pok_19
  buffer_load_dwordx2 v[138:139], v166, s[4:7], 0 offen sc1
  s_waitcnt vmcnt(0)
  s_branch concat_heads__linear_kernel_hedgehog__softmax_full_mha__prompt_kernel_plp_20
concat_heads__linear_kernel_hedgehog__softmax_full_mha__prompt_kernel_pok_19:
  s_lshl_b32 s56, s32, 6
  s_add_u32 s56, s56, s65
  s_lshl_b32 s57, s56, 10
  s_add_u32 s58, s57, 2097152
  s_mul_i32 s59, s65, 2304
  s_add_u32 s59, s59, s63
  s_sub_u32 s59, s59, 8388608
  s_sub_u32 s56, s66, 8388608
  s_add_u32 s60, s56, 262144
  buffer_load_dwordx2 v[16:17], v15, s[4:7], s58 offen offset:0 sc1
  buffer_load_dwordx2 v[18:19], v15, s[4:7], s58 offen offset:512 sc1
  buffer_load_dword v20, v167, s[4:7], s60 offen offset:0 sc1
  buffer_load_dwordx2 v[36:37], v15, s[4:7], s58 offen offset:1024 sc1
  buffer_load_dwordx2 v[38:39], v15, s[4:7], s58 offen offset:1536 sc1
  buffer_load_dword v40, v167, s[4:7], s60 offen offset:256 sc1
  buffer_load_dwordx2 v[22:23], v15, s[4:7], s57 offen offset:0 sc1
  buffer_load_dwordx2 v[24:25], v15, s[4:7], s57 offen offset:512 sc1
  buffer_load_dword v26, v167, s[4:7], s56 offen offset:0 sc1
  buffer_load_dwordx2 v[42:43], v15, s[4:7], s57 offen offset:1024 sc1
  buffer_load_dwordx2 v[44:45], v15, s[4:7], s57 offen offset:1536 sc1
  buffer_load_dword v46, v167, s[4:7], s56 offen offset:256 sc1
  s_mov_b64 exec, s[28:29]
  buffer_load_dwordx4 v[28:31], v158, s[4:7], s59 offen offset:0 sc1
  buffer_load_dwordx4 v[32:35], v159, s[4:7], s59 offen offset:0 sc1
  buffer_load_dwordx4 v[48:51], v158, s[4:7], s59 offen offset:2304 sc1
  buffer_load_dwordx4 v[52:55], v159, s[4:7], s59 offen offset:2304 sc1
  s_mov_b64 exec, -1
  v_and_b32 v2, 7, v0
  v_lshlrev_b32 v2, 2, v2
  v_add_u32 v2, 161520, v2
  s_mov_b32 s61, 1048576
concat_heads__linear_kernel_hedgehog__softmax_full_mha__prompt_kernel_gb_21:
  ds_read_b32 v3, v2
  s_sub_u32 s61, s61, 1
  s_waitcnt lgkmcnt(0)
  s_cbranch_scc1 concat_heads__linear_kernel_hedgehog__softmax_full_mha__prompt_kernel_gb_21x
  v_cmp_ne_u32 vcc, 0, v3
  s_cbranch_vccz concat_heads__linear_kernel_hedgehog__softmax_full_mha__prompt_kernel_gb_21x
  s_sleep 2
  s_branch concat_heads__linear_kernel_hedgehog__softmax_full_mha__prompt_kernel_gb_21
concat_heads__linear_kernel_hedgehog__softmax_full_mha__prompt_kernel_gb_21x:
  s_add_u32 m0, s27, 4294947840
  s_add_u32 s56, s68, 4294950912
  buffer_load_dwordx4 v1, s[4:7], s56 offen sc1 lds
  s_add_u32 m0, s27, 0
  s_add_u32 s56, s68, 16384
  buffer_load_dwordx4 v1, s[4:7], s56 offen sc1 lds
  s_add_u32 m0, s27, 4294951936
  s_add_u32 s56, s68, 4294955008
  buffer_load_dwordx4 v1, s[4:7], s56 offen sc1 lds
  s_add_u32 m0, s27, 4096
  s_add_u32 s56, s68, 20480
  buffer_load_dwordx4 v1, s[4:7], s56 offen sc1 lds
  s_add_u32 m0, s27, 4294956032
  s_add_u32 s56, s69, 4294930432
  buffer_load_dwordx4 v154, s[4:7], s56 offen sc1 lds
  s_add_u32 m0, s27, 8192
  s_add_u32 s56, s69, 36864
  buffer_load_dwordx4 v154, s[4:7], s56 offen sc1 lds
  s_add_u32 m0, s27, 4294960128
  s_add_u32 s56, s69, 4294930432
  buffer_load_dwordx4 v155, s[4:7], s56 offen sc1 lds
  s_add_u32 m0, s27, 12288
  s_add_u32 s56, s69, 36864
  buffer_load_dwordx4 v155, s[4:7], s56 offen sc1 lds
  s_add_u32 m0, s35, 4294947840
  s_mul_i32 s56, s96, 16
  s_add_u32 s56, s56, s67
  buffer_load_dwordx4 v156, s[4:7], s56 offen sc1 lds
  s_add_u32 m0, s35, 0
  s_mul_i32 s56, s96, 48
  s_add_u32 s56, s56, s67
  buffer_load_dwordx4 v156, s[4:7], s56 offen sc1 lds
  s_add_u32 m0, s97, 161440
  s_mov_b64 exec, 1
  buffer_load_dword v0, s[12:15], 0 offen lds
  s_mov_b64 exec, -1
  s_mov_b32 s94, 1069066811
  s_mov_b32 s95, 1069066811
  s_mov_b32 s57, s24
  s_mul_i32 s56, s57, 5120
  s_add_u32 s56, s56, 77824
  s_waitcnt vmcnt(11)
  v_mfma_f32_32x32x16_bf16 v[56:71], v[148:151], v[16:19], 0
  v_mfma_f32_32x32x16_bf16 v[86:101], v[148:151], v[36:39], 0
  v_mfma_f32_32x32x8_bf16 v[56:71], v[152:153], v[20:21], v[56:71]
  v_mfma_f32_32x32x8_bf16 v[86:101], v[152:153], v[40:41], v[86:101]
  v_and_b32 v2, 16, v9
  v_and_b32 v3, 3, v9
  v_lshl_add_u32 v2, v3, 2, v2
  v_bfe_u32 v3, v9, 2, 2
  v_add_u32 v2, v2, v3
  v_mul_u32_u24 v2, 80, v2
  v_lshl_add_u32 v2, v8, 3, v2
  v_add_u32 v2, s56, v2
  v_bfe_u32 v3, v0, 2, 2
  v_lshl_add_u32 v3, v3, 1, v8
  v_mul_u32_u24 v3, 160, v3
  v_add_u32 v3, s56, v3
  v_max3_f32 v82, v56, v57, v58
  v_max3_f32 v112, v86, v87, v88
  v_max3_f32 v84, -v56, -v57, -v58
  v_max3_f32 v114, -v86, -v87, -v88
  v_max3_f32 v82, v82, v59, v60
  v_max3_f32 v112, v112, v89, v90
  v_max3_f32 v84, v84, -v59, -v60
  v_max3_f32 v114, v114, -v89, -v90
  v_max3_f32 v82, v82, v61, v62
  v_max3_f32 v112, v112, v91, v92
  v_max3_f32 v84, v84, -v61, -v62
  v_max3_f32 v114, v114, -v91, -v92
  v_max3_f32 v82, v82, v63, v64
  v_max3_f32 v112, v112, v93, v94
  v_max3_f32 v84, v84, -v63, -v64
  v_max3_f32 v114, v114, -v93, -v94
  s_nop 0
  v_permlane32_swap_b32 v82, v84
  v_permlane32_swap_b32 v112, v114
  v_max_f32 v82, v82, v84
  v_max_f32 v112, v112, v114
  v_mul_f32 v82, s94, v82
  v_mul_f32 v112, s94, v112
  v_mov_b32 v84, v82
  v_mov_b32 v114, v112
  s_nop 0
  v_permlane32_swap_b32 v82, v84
  v_permlane32_swap_b32 v112, v114
  v_fma_f32 v72, v56, s94, -v82
  v_fma_f32 v102, v86, s94, -v112
  v_fma_f32 v73, v57, s94, -v82
  v_fma_f32 v103, v87, s94, -v112
  v_fma_f32 v74, v58, s94, -v82
  v_fma_f32 v104, v88, s94, -v112
  v_fma_f32 v75, v59, s94, -v82
  v_fma_f32 v105, v89, s94, -v112
  v_fma_f32 v76, v60, s94, -v82
  v_fma_f32 v106, v90, s94, -v112
  v_fma_f32 v77, v61, s94, -v82
  v_fma_f32 v107, v91, s94, -v112
  v_fma_f32 v78, v62, s94, -v82
  v_fma_f32 v108, v92, s94, -v112
  v_fma_f32 v79, v63, s94, -v82
  v_fma_f32 v109, v93, s94, -v112
  v_fma_f32 v80, v64, s94, -v82
  v_fma_f32 v110, v94, s94, -v112
  v_fma_f32 v56, -v56, s94, -v84
  v_fma_f32 v86, -v86, s94, -v114
  v_fma_f32 v57, -v57, s94, -v84
  v_fma_f32 v87, -v87, s94, -v114
  v_fma_f32 v58, -v58, s94, -v84
  v_fma_f32 v88, -v88, s94, -v114
  v_fma_f32 v59, -v59, s94, -v84
  v_fma_f32 v89, -v89, s94, -v114
  v_fma_f32 v60, -v60, s94, -v84
  v_fma_f32 v90, -v90, s94, -v114
  v_fma_f32 v61, -v61, s94, -v84
  v_fma_f32 v91, -v91, s94, -v114
  v_fma_f32 v62, -v62, s94, -v84
  v_fma_f32 v92, -v92, s94, -v114
  v_fma_f32 v63, -v63, s94, -v84
  v_fma_f32 v93, -v93, s94, -v114
  v_fma_f32 v64, -v64, s94, -v84
  v_fma_f32 v94, -v94, s94, -v114
  v_exp_f32 v72, v72
  v_exp_f32 v102, v102
  v_exp_f32 v73, v73
  v_exp_f32 v103, v103
  v_exp_f32 v74, v74
  v_exp_f32 v104, v104
  v_exp_f32 v75, v75
  v_exp_f32 v105, v105
  v_exp_f32 v76, v76
  v_exp_f32 v106, v106
  v_exp_f32 v77, v77
  v_exp_f32 v107, v107
  v_exp_f32 v78, v78
  v_exp_f32 v108, v108
  v_exp_f32 v79, v79
  v_exp_f32 v109, v109
  v_exp_f32 v80, v80
  v_exp_f32 v110, v110
  v_exp_f32 v56, v56
  v_exp_f32 v86, v86
  v_exp_f32 v57, v57
  v_exp_f32 v87, v87
  v_exp_f32 v58, v58
  v_exp_f32 v88, v88
  v_exp_f32 v59, v59
  v_exp_f32 v89, v89
  v_exp_f32 v60, v60
  v_exp_f32 v90, v90
  v_exp_f32 v61, v61
  v_exp_f32 v91, v91
  v_exp_f32 v62, v62
  v_exp_f32 v92, v92
  v_exp_f32 v63, v63
  v_exp_f32 v93, v93
  v_exp_f32 v64, v64
  v_exp_f32 v94, v94
  v_add_f32 v82, v72, v74
  v_add_f32 v83, v73, v75
  v_add_f32 v112, v102, v104
  v_add_f32 v113, v103, v105
  v_add_f32 v84, v56, v58
  v_add_f32 v85, v57, v59
  v_add_f32 v114, v86, v88
  v_add_f32 v115, v87, v89
  v_add_f32 v82, v82, v76
  v_add_f32 v83, v83, v77
  v_add_f32 v112, v112, v106
  v_add_f32 v113, v113, v107
  v_add_f32 v84, v84, v60
  v_add_f32 v85, v85, v61
  v_add_f32 v114, v114, v90
  v_add_f32 v115, v115, v91
  v_add_f32 v82, v82, v78
  v_add_f32 v83, v83, v79
  v_add_f32 v112, v112, v108
  v_add_f32 v113, v113, v109
  v_add_f32 v84, v84, v62
  v_add_f32 v85, v85, v63
  v_add_f32 v114, v114, v92
  v_add_f32 v115, v115, v93
  v_add_f32 v82, v82, v80
  v_add_f32 v112, v112, v110
  v_add_f32 v84, v84, v64
  v_add_f32 v114, v114, v94
  v_add_f32 v82, v82, v83
  v_add_f32 v112, v112, v113
  v_add_f32 v84, v84, v85
  v_add_f32 v114, v114, v115
  s_nop 0
  v_permlane32_swap_b32 v82, v84
  v_permlane32_swap_b32 v112, v114
  v_add_f32 v82, v82, v84
  v_add_f32 v112, v112, v114
  v_rcp_f32 v82, v82
  v_rcp_f32 v112, v112
  v_mov_b32 v84, v82
  v_mov_b32 v114, v112
  s_nop 0
  v_permlane32_swap_b32 v82, v84
  v_permlane32_swap_b32 v112, v114
  v_mul_f32 v72, v72, v82
  v_mul_f32 v73, v73, v82
  v_mul_f32 v102, v102, v112
  v_mul_f32 v103, v103, v112
  v_mul_f32 v74, v74, v82
  v_mul_f32 v75, v75, v82
  v_mul_f32 v104, v104, v112
  v_mul_f32 v105, v105, v112
  v_mul_f32 v76, v76, v82
  v_mul_f32 v77, v77, v82
  v_mul_f32 v106, v106, v112
  v_mul_f32 v107, v107, v112
  v_mul_f32 v78, v78, v82
  v_mul_f32 v79, v79, v82
  v_mul_f32 v108, v108, v112
  v_mul_f32 v109, v109, v112
  v_mul_f32 v56, v56, v84
  v_mul_f32 v57, v57, v84
  v_mul_f32 v86, v86, v114
  v_mul_f32 v87, v87, v114
  v_mul_f32 v58, v58, v84
  v_mul_f32 v59, v59, v84
  v_mul_f32 v88, v88, v114
  v_mul_f32 v89, v89, v114
  v_mul_f32 v60, v60, v84
  v_mul_f32 v61, v61, v84
  v_mul_f32 v90, v90, v114
  v_mul_f32 v91, v91, v114
  v_mul_f32 v62, v62, v84
  v_mul_f32 v63, v63, v84
  v_mul_f32 v92, v92, v114
  v_mul_f32 v93, v93, v114
  v_mul_f32 v80, v80, v82
  v_mul_f32 v110, v110, v112
  v_mul_f32 v64, v64, v84
  v_mul_f32 v94, v94, v114
  v_cvt_pk_bf16_f32 v116, v72, v73
  v_cvt_pk_bf16_f32 v126, v102, v103
  v_cvt_pk_bf16_f32 v117, v74, v75
  v_cvt_pk_bf16_f32 v127, v104, v105
  v_cvt_pk_bf16_f32 v118, v76, v77
  v_cvt_pk_bf16_f32 v128, v106, v107
  v_cvt_pk_bf16_f32 v119, v78, v79
  v_cvt_pk_bf16_f32 v129, v108, v109
  v_cvt_pk_bf16_f32 v120, v56, v57
  v_cvt_pk_bf16_f32 v130, v86, v87
  v_cvt_pk_bf16_f32 v121, v58, v59
  v_cvt_pk_bf16_f32 v131, v88, v89
  v_cvt_pk_bf16_f32 v122, v60, v61
  v_cvt_pk_bf16_f32 v132, v90, v91
  v_cvt_pk_bf16_f32 v123, v62, v63
  v_cvt_pk_bf16_f32 v133, v92, v93
  v_cvt_pk_bf16_f32 v124, v80, v64
  v_cvt_pk_bf16_f32 v134, v110, v94
  v_mov_b32 v125, 0
  v_mov_b32 v135, 0
  ds_write_b64 v2, v[116:117] offset:0
  ds_write_b64 v2, v[118:119] offset:16
  ds_write_b64 v2, v[120:121] offset:32
  ds_write_b64 v2, v[122:123] offset:48
  ds_write_b64 v2, v[124:125] offset:64
  ds_write_b64 v2, v[126:127] offset:2560
  ds_write_b64 v2, v[128:129] offset:2576
  ds_write_b64 v2, v[130:131] offset:2592
  ds_write_b64 v2, v[132:133] offset:2608
  ds_write_b64 v2, v[134:135] offset:2624
  v_mfma_f32_32x32x16_bf16 v[56:71], v[148:151], v[22:25], 0
  v_mfma_f32_32x32x16_bf16 v[86:101], v[148:151], v[42:45], 0
  v_mfma_f32_32x32x8_bf16 v[56:71], v[152:153], v[26:27], v[56:71]
  v_mfma_f32_32x32x8_bf16 v[86:101], v[152:153], v[46:47], v[86:101]
  v_and_b32 v4, 1, v0
  v_lshl_add_u32 v4, v4, 3, v3
  v_and_b32 v5, 3, v0
  v_lshl_add_u32 v3, v5, 3, v3
  v_bfe_u32 v5, v0, 4, 1
  v_lshl_add_u32 v3, v5, 5, v3
  v_min_u32 v167, 18, v9
  v_mad_u32_u24 v167, v8, 19, v167
  v_mul_u32_u24 v167, 80, v167
  v_add_u32 v6, s56, v167
  v_min_u32 v166, 47, v0
  v_mad_u32_u24 v166, s57, 48, v166
  v_lshlrev_b32 v166, 4, v166
  s_waitcnt lgkmcnt(0)
  ds_read_b64_tr_b16 v[116:117], v3 offset:0
  ds_read_b64_tr_b16 v[120:121], v4 offset:64
  ds_read_b64_tr_b16 v[118:119], v3 offset:80
  ds_read_b64_tr_b16 v[122:123], v4 offset:144
  ds_read_b64_tr_b16 v[124:125], v3 offset:1280
  ds_read_b64_tr_b16 v[128:129], v4 offset:1344
  ds_read_b64_tr_b16 v[126:127], v3 offset:1360
  ds_read_b64_tr_b16 v[130:131], v4 offset:1424
  ds_read_b64_tr_b16 v[132:133], v3 offset:2560
  ds_read_b64_tr_b16 v[136:137], v4 offset:2624
  ds_read_b64_tr_b16 v[134:135], v3 offset:2640
  ds_read_b64_tr_b16 v[138:139], v4 offset:2704
  ds_read_b64_tr_b16 v[140:141], v3 offset:3840
  ds_read_b64_tr_b16 v[144:145], v4 offset:3904
  ds_read_b64_tr_b16 v[142:143], v3 offset:3920
  ds_read_b64_tr_b16 v[146:147], v4 offset:3984
  v_max3_f32 v82, v56, v57, v58
  v_max3_f32 v112, v86, v87, v88
  v_max3_f32 v84, -v56, -v57, -v58
  v_max3_f32 v114, -v86, -v87, -v88
  v_max3_f32 v82, v82, v59, v60
  v_max3_f32 v112, v112, v89, v90
  v_max3_f32 v84, v84, -v59, -v60
  v_max3_f32 v114, v114, -v89, -v90
  v_max3_f32 v82, v82, v61, v62
  v_max3_f32 v112, v112, v91, v92
  v_max3_f32 v84, v84, -v61, -v62
  v_max3_f32 v114, v114, -v91, -v92
  v_max3_f32 v82, v82, v63, v64
  v_max3_f32 v112, v112, v93, v94
  v_max3_f32 v84, v84, -v63, -v64
  v_max3_f32 v114, v114, -v93, -v94
  s_nop 0
  v_permlane32_swap_b32 v82, v84
  v_permlane32_swap_b32 v112, v114
  v_max_f32 v82, v82, v84
  v_max_f32 v112, v112, v114
  v_mul_f32 v82, s94, v82
  v_mul_f32 v112, s94, v112
  v_mov_b32 v84, v82
  v_mov_b32 v114, v112
  s_nop 0
  v_permlane32_swap_b32 v82, v84
  v_permlane32_swap_b32 v112, v114
  v_fma_f32 v72, v56, s94, -v82
  v_fma_f32 v102, v86, s94, -v112
  v_fma_f32 v73, v57, s94, -v82
  v_fma_f32 v103, v87, s94, -v112
  v_fma_f32 v74, v58, s94, -v82
  v_fma_f32 v104, v88, s94, -v112
  v_fma_f32 v75, v59, s94, -v82
  v_fma_f32 v105, v89, s94, -v112
  v_fma_f32 v76, v60, s94, -v82
  v_fma_f32 v106, v90, s94, -v112
  v_fma_f32 v77, v61, s94, -v82
  v_fma_f32 v107, v91, s94, -v112
  v_fma_f32 v78, v62, s94, -v82
  v_fma_f32 v108, v92, s94, -v112
  v_fma_f32 v79, v63, s94, -v82
  v_fma_f32 v109, v93, s94, -v112
  v_fma_f32 v80, v64, s94, -v82
  v_fma_f32 v110, v94, s94, -v112
  v_fma_f32 v56, -v56, s94, -v84
  v_fma_f32 v86, -v86, s94, -v114
  v_fma_f32 v57, -v57, s94, -v84
  v_fma_f32 v87, -v87, s94, -v114
  v_fma_f32 v58, -v58, s94, -v84
  v_fma_f32 v88, -v88, s94, -v114
  v_fma_f32 v59, -v59, s94, -v84
  v_fma_f32 v89, -v89, s94, -v114
  v_fma_f32 v60, -v60, s94, -v84
  v_fma_f32 v90, -v90, s94, -v114
  v_fma_f32 v61, -v61, s94, -v84
  v_fma_f32 v91, -v91, s94, -v114
  v_fma_f32 v62, -v62, s94, -v84
  v_fma_f32 v92, -v92, s94, -v114
  v_fma_f32 v63, -v63, s94, -v84
  v_fma_f32 v93, -v93, s94, -v114
  v_fma_f32 v64, -v64, s94, -v84
  v_fma_f32 v94, -v94, s94, -v114
  v_exp_f32 v72, v72
  v_exp_f32 v102, v102
  v_exp_f32 v73, v73
  v_exp_f32 v103, v103
  v_exp_f32 v74, v74
  v_exp_f32 v104, v104
  v_exp_f32 v75, v75
  v_exp_f32 v105, v105
  v_exp_f32 v76, v76
  v_exp_f32 v106, v106
  v_exp_f32 v77, v77
  v_exp_f32 v107, v107
  v_exp_f32 v78, v78
  v_exp_f32 v108, v108
  v_exp_f32 v79, v79
  v_exp_f32 v109, v109
  v_exp_f32 v80, v80
  v_exp_f32 v110, v110
  v_exp_f32 v56, v56
  v_exp_f32 v86, v86
  v_exp_f32 v57, v57
  v_exp_f32 v87, v87
  v_exp_f32 v58, v58
  v_exp_f32 v88, v88
  v_exp_f32 v59, v59
  v_exp_f32 v89, v89
  v_exp_f32 v60, v60
  v_exp_f32 v90, v90
  v_exp_f32 v61, v61
  v_exp_f32 v91, v91
  v_exp_f32 v62, v62
  v_exp_f32 v92, v92
  v_exp_f32 v63, v63
  v_exp_f32 v93, v93
  v_exp_f32 v64, v64
  v_exp_f32 v94, v94
  v_add_f32 v82, v72, v74
  v_add_f32 v83, v73, v75
  v_add_f32 v112, v102, v104
  v_add_f32 v113, v103, v105
  v_add_f32 v84, v56, v58
  v_add_f32 v85, v57, v59
  v_add_f32 v114, v86, v88
  v_add_f32 v115, v87, v89
  v_add_f32 v82, v82, v76
  v_add_f32 v83, v83, v77
  v_add_f32 v112, v112, v106
  v_add_f32 v113, v113, v107
  v_add_f32 v84, v84, v60
  v_add_f32 v85, v85, v61
  v_add_f32 v114, v114, v90
  v_add_f32 v115, v115, v91
  v_add_f32 v82, v82, v78
  v_add_f32 v83, v83, v79
  v_add_f32 v112, v112, v108
  v_add_f32 v113, v113, v109
  v_add_f32 v84, v84, v62
  v_add_f32 v85, v85, v63
  v_add_f32 v114, v114, v92
  v_add_f32 v115, v115, v93
  v_add_f32 v82, v82, v80
  v_add_f32 v112, v112, v110
  v_add_f32 v84, v84, v64
  v_add_f32 v114, v114, v94
  v_add_f32 v82, v82, v83
  v_add_f32 v112, v112, v113
  v_add_f32 v84, v84, v85
  v_add_f32 v114, v114, v115
  s_nop 0
  v_permlane32_swap_b32 v82, v84
  v_permlane32_swap_b32 v112, v114
  v_add_f32 v82, v82, v84
  v_add_f32 v112, v112, v114
  v_rcp_f32 v82, v82
  v_rcp_f32 v112, v112
  v_mov_b32 v84, v82
  v_mov_b32 v114, v112
  s_nop 0
  v_permlane32_swap_b32 v82, v84
  v_permlane32_swap_b32 v112, v114
  v_mul_f32 v72, v72, v82
  v_mul_f32 v73, v73, v82
  v_mul_f32 v102, v102, v112
  v_mul_f32 v103, v103, v112
  v_mul_f32 v74, v74, v82
  v_mul_f32 v75, v75, v82
  v_mul_f32 v104, v104, v112
  v_mul_f32 v105, v105, v112
  v_mul_f32 v76, v76, v82
  v_mul_f32 v77, v77, v82
  v_mul_f32 v106, v106, v112
  v_mul_f32 v107, v107, v112
  v_mul_f32 v78, v78, v82
  v_mul_f32 v79, v79, v82
  v_mul_f32 v108, v108, v112
  v_mul_f32 v109, v109, v112
  v_mul_f32 v56, v56, v84
  v_mul_f32 v57, v57, v84
  v_mul_f32 v86, v86, v114
  v_mul_f32 v87, v87, v114
  v_mul_f32 v58, v58, v84
  v_mul_f32 v59, v59, v84
  v_mul_f32 v88, v88, v114
  v_mul_f32 v89, v89, v114
  v_mul_f32 v60, v60, v84
  v_mul_f32 v61, v61, v84
  v_mul_f32 v90, v90, v114
  v_mul_f32 v91, v91, v114
  v_mul_f32 v62, v62, v84
  v_mul_f32 v63, v63, v84
  v_mul_f32 v92, v92, v114
  v_mul_f32 v93, v93, v114
  v_mul_f32 v80, v80, v82
  v_mul_f32 v110, v110, v112
  v_mul_f32 v64, v64, v84
  v_mul_f32 v94, v94, v114
  v_cvt_pk_bf16_f32 v16, v72, v73
  v_cvt_pk_bf16_f32 v36, v102, v103
  v_cvt_pk_bf16_f32 v17, v74, v75
  v_cvt_pk_bf16_f32 v37, v104, v105
  v_cvt_pk_bf16_f32 v18, v76, v77
  v_cvt_pk_bf16_f32 v38, v106, v107
  v_cvt_pk_bf16_f32 v19, v78, v79
  v_cvt_pk_bf16_f32 v39, v108, v109
  v_cvt_pk_bf16_f32 v20, v56, v57
  v_cvt_pk_bf16_f32 v40, v86, v87
  v_cvt_pk_bf16_f32 v21, v58, v59
  v_cvt_pk_bf16_f32 v41, v88, v89
  v_cvt_pk_bf16_f32 v22, v60, v61
  v_cvt_pk_bf16_f32 v42, v90, v91
  v_cvt_pk_bf16_f32 v23, v62, v63
  v_cvt_pk_bf16_f32 v43, v92, v93
  v_cvt_pk_bf16_f32 v24, v80, v64
  v_cvt_pk_bf16_f32 v44, v110, v94
  v_mov_b32 v25, 0
  v_mov_b32 v45, 0
  s_waitcnt lgkmcnt(0)
  v_mfma_f32_32x32x16_bf16 v[56:71], v[116:119], v[28:31], 0
  v_mfma_f32_32x32x16_bf16 v[72:87], v[120:123], v[28:31], 0
  v_mfma_f32_32x32x16_bf16 v[56:71], v[124:127], v[32:35], v[56:71]
  v_mfma_f32_32x32x16_bf16 v[72:87], v[128:131], v[32:35], v[72:87]
  v_mfma_f32_32x32x16_bf16 v[56:71], v[132:135], v[48:51], v[56:71]
  v_mfma_f32_32x32x16_bf16 v[72:87], v[136:139], v[48:51], v[72:87]
  v_mfma_f32_32x32x16_bf16 v[56:71], v[140:143], v[52:55], v[56:71]
  v_mfma_f32_32x32x16_bf16 v[72:87], v[144:147], v[52:55], v[72:87]
  s_mov_b32 exec_lo, 0x7ffff
  s_mov_b32 exec_hi, 0x7ffff
  s_nop 8
  ds_write_b128 v6, v[56:59] offset:0
  ds_write_b128 v6, v[60:63] offset:16
  ds_write_b128 v6, v[64:67] offset:32
  ds_write_b128 v6, v[68:71] offset:48
  ds_write_b128 v6, v[72:75] offset:64
  s_mov_b64 exec, -1
  s_waitcnt lgkmcnt(0)
  v_mov_b32 v2, 160768
  v_mov_b32 v3, 1
  s_mov_b64 exec, 1
  ds_add_u32 v2, v3
  s_mov_b64 exec, -1
  s_mov_b32 s61, 1048576
concat_heads__linear_kernel_hedgehog__softmax_full_mha__prompt_kernel_gb_22:
  ds_read_b32 v3, v2
  s_sub_u32 s61, s61, 1
  s_waitcnt lgkmcnt(0)
  s_cbranch_scc1 concat_heads__linear_kernel_hedgehog__softmax_full_mha__prompt_kernel_gb_22x
  v_cmp_gt_u32 vcc, 8, v3
  s_cbranch_vccz concat_heads__linear_kernel_hedgehog__softmax_full_mha__prompt_kernel_gb_22x
  s_branch concat_heads__linear_kernel_hedgehog__softmax_full_mha__prompt_kernel_gb_22
concat_heads__linear_kernel_hedgehog__softmax_full_mha__prompt_kernel_gb_22x:
  v_add_u32 v2, 77824, v166
  ds_read_b128 v[56:59], v2 offset:0
  ds_read_b128 v[60:63], v2 offset:5120
  ds_read_b128 v[64:67], v2 offset:10240
  ds_read_b128 v[68:71], v2 offset:15360
  s_lshl_b32 s56, s32, 3
  s_add_u32 s56, s56, s33
  s_mul_i32 s56, s56, 3072
  s_add_u32 s56, s56, 25165824
  s_waitcnt lgkmcnt(0)
  v_add_f32 v56, v56, v60
  v_add_f32 v57, v57, v61
  v_add_f32 v58, v58, v62
  v_add_f32 v59, v59, v63
  v_add_f32 v56, v56, v64
  v_add_f32 v57, v57, v65
  v_add_f32 v58, v58, v66
  v_add_f32 v59, v59, v67
  v_add_f32 v56, v56, v68
  v_add_f32 v57, v57, v69
  v_add_f32 v58, v58, v70
  v_add_f32 v59, v59, v71
  buffer_store_dwordx4 v[56:59], v166, s[4:7], s56 offen sc1
  v_and_b32 v2, 7, v0
  v_lshlrev_b32 v2, 9, v2
  s_lshl_b32 s56, s32, 12
  s_lshl_b32 s57, s24, 7
  s_add_u32 s56, s56, s57
  s_add_u32 s56, s56, 27525120
  v_add_u32 v140, s56, v2
  s_lshl_b32 s56, s32, 3
  s_add_u32 s56, s56, s33
  s_lshl_b32 s56, s56, 9
  s_add_u32 s56, s56, 27525120
  s_lshl_b32 s57, s24, 7
  s_add_u32 s56, s56, s57
  s_waitcnt vmcnt(0)
  v_mov_b32 v136, s25
  v_mov_b32 v137, s26
  v_mov_b32 v138, s25
  v_mov_b32 v139, s26
  s_mov_b64 exec, 0xff
  buffer_store_dwordx4 v[136:139], v1, s[4:7], s56 offen sc1
  s_mov_b64 exec, -1
  s_nop 0
  s_lshl_b32 s57, s24, 10
  s_add_u32 m0, s57, 114688
  s_add_u32 s56, s3, 331776
  buffer_load_dwordx4 v160, s[8:11], s56 offen lds
  s_lshl_b32 s57, s24, 10
  s_add_u32 m0, s57, 118784
  s_add_u32 s56, s3, 331776
  buffer_load_dwordx4 v161, s[8:11], s56 offen lds
  s_lshl_b32 s57, s24, 10
  s_add_u32 m0, s57, 123904
  s_add_u32 s56, s3, 414720
  buffer_load_dwordx4 v160, s[8:11], s56 offen lds
  s_lshl_b32 s57, s24, 10
  s_add_u32 m0, s57, 128000
  s_add_u32 s56, s3, 414720
  buffer_load_dwordx4 v161, s[8:11], s56 offen lds
  s_lshl_b32 s57, s24, 10
  s_add_u32 m0, s57, 133120
  s_add_u32 s56, s3, 497664
  buffer_load_dwordx4 v160, s[8:11], s56 offen lds
  s_lshl_b32 s57, s24, 10
  s_add_u32 m0, s57, 137216
  s_add_u32 s56, s3, 497664
  buffer_load_dwordx4 v161, s[8:11], s56 offen lds
  s_lshl_b32 s57, s24, 10
  s_add_u32 m0, s57, 142336
  s_add_u32 s56, s3, 580608
  buffer_load_dwordx4 v160, s[8:11], s56 offen lds
  s_lshl_b32 s57, s24, 10
  s_add_u32 m0, s57, 146432
  s_add_u32 s56, s3, 580608
  buffer_load_dwordx4 v161, s[8:11], s56 offen lds
  s_lshl_b32 s57, s24, 10
  s_add_u32 m0, s57, 151552
  s_add_u32 s56, s3, 0
  buffer_load_dwordx4 v163, s[8:11], s56 offen lds
  s_lshl_b32 s57, s24, 10
  s_add_u32 m0, s57, 155648
  s_add_u32 s56, s3, 0
  buffer_load_dwordx4 v164, s[8:11], s56 offen lds
  s_mov_b32 m0, 159744
  s_nop 0
  buffer_load_dwordx4 v165, s[8:11], s3 offen lds
  s_sub_u32 s57, s24, 0
  s_lshl_b32 s57, s57, 2
  s_lshr_b32 s56, 30292, s57
  s_and_b32 s56, s56, 15
  s_mul_i32 s56, s56, 9216
  s_add_u32 m0, s56, 86016
  s_lshr_b32 s56, 30292, s57
  s_and_b32 s56, s56, 15
  s_mul_i32 s56, s56, 82944
  s_add_u32 s56, s56, s3
  buffer_load_dwordx4 v162, s[8:11], s56 offen lds
  buffer_load_dwordx2 v[138:139], v140, s[4:7], 0 offen sc1
  s_waitcnt vmcnt(0)
  s_mov_b32 s61, 1048576
concat_heads__linear_kernel_hedgehog__softmax_full_mha__prompt_kernel_plp_24:
  v_cmp_eq_u32 vcc, s25, v138
  v_cmp_eq_u32 s[94:95], s26, v139
  s_and_b64 vcc, vcc, s[94:95]
  s_cmp_eq_u64 vcc, -1
  s_cbranch_scc1 concat_heads__linear_kernel_hedgehog__softmax_full_mha__prompt_kernel_pok_23
  s_sub_u32 s61, s61, 1
  s_cbranch_scc1 concat_heads__linear_kernel_hedgehog__softmax_full_mha__prompt_kernel_pok_23
  buffer_load_dwordx2 v[138:139], v140, s[4:7], 0 offen sc1
  s_waitcnt vmcnt(0)
  s_branch concat_heads__linear_kernel_hedgehog__softmax_full_mha__prompt_kernel_plp_24
concat_heads__linear_kernel_hedgehog__softmax_full_mha__prompt_kernel_pok_23:
  s_mul_i32 s56, s32, 24576
  s_add_u32 s56, s56, 25165824
  buffer_load_dwordx4 v[56:59], v166, s[4:7], s56 offen sc1
  s_add_u32 s56, s56, 3072
  buffer_load_dwordx4 v[60:63], v166, s[4:7], s56 offen sc1
  s_add_u32 s56, s56, 3072
  buffer_load_dwordx4 v[64:67], v166, s[4:7], s56 offen sc1
  s_add_u32 s56, s56, 3072
  buffer_load_dwordx4 v[68:71], v166, s[4:7], s56 offen sc1
  s_add_u32 s56, s56, 3072
  buffer_load_dwordx4 v[72:75], v166, s[4:7], s56 offen sc1
  s_add_u32 s56, s56, 3072
  buffer_load_dwordx4 v[76:79], v166, s[4:7], s56 offen sc1
  s_add_u32 s56, s56, 3072
  buffer_load_dwordx4 v[80:83], v166, s[4:7], s56 offen sc1
  s_add_u32 s56, s56, 3072
  buffer_load_dwordx4 v[84:87], v166, s[4:7], s56 offen sc1
  s_add_u32 s56, s56, 3072
  s_mov_b32 s20, s48
  s_mov_b32 s21, s49
  s_mov_b32 s22, 663552
  s_mov_b32 s23, 0x20000
  v_and_b32 v2, 7, v0
  v_lshlrev_b32 v2, 2, v2
  v_add_u32 v2, 161552, v2
  s_mov_b32 s61, 1048576
concat_heads__linear_kernel_hedgehog__softmax_full_mha__prompt_kernel_gb_25:
  ds_read_b32 v3, v2
  s_sub_u32 s61, s61, 1
  s_waitcnt lgkmcnt(0)
  s_cbranch_scc1 concat_heads__linear_kernel_hedgehog__softmax_full_mha__prompt_kernel_gb_25x
  v_cmp_ne_u32 vcc, 0, v3
  s_cbranch_vccz concat_heads__linear_kernel_hedgehog__softmax_full_mha__prompt_kernel_gb_25x
  s_sleep 2
  s_branch concat_heads__linear_kernel_hedgehog__softmax_full_mha__prompt_kernel_gb_25
concat_heads__linear_kernel_hedgehog__softmax_full_mha__prompt_kernel_gb_25x:
  s_add_u32 m0, s27, 19456
  s_add_u32 s56, s68, 4294959104
  buffer_load_dwordx4 v1, s[4:7], s56 offen sc1 lds
  s_add_u32 m0, s27, 38912
  s_add_u32 s56, s68, 24576
  buffer_load_dwordx4 v1, s[4:7], s56 offen sc1 lds
  s_add_u32 m0, s27, 23552
  s_add_u32 s56, s68, 4294963200
  buffer_load_dwordx4 v1, s[4:7], s56 offen sc1 lds
  s_add_u32 m0, s27, 43008
  s_add_u32 s56, s68, 28672
  buffer_load_dwordx4 v1, s[4:7], s56 offen sc1 lds
  s_add_u32 m0, s27, 27648
  s_add_u32 s56, s69, 4294948864
  buffer_load_dwordx4 v154, s[4:7], s56 offen sc1 lds
  s_add_u32 m0, s27, 47104
  s_add_u32 s56, s69, 55296
  buffer_load_dwordx4 v154, s[4:7], s56 offen sc1 lds
  s_add_u32 m0, s27, 31744
  s_add_u32 s56, s69, 4294948864
  buffer_load_dwordx4 v155, s[4:7], s56 offen sc1 lds
  s_add_u32 m0, s27, 51200
  s_add_u32 s56, s69, 55296
  buffer_load_dwordx4 v155, s[4:7], s56 offen sc1 lds
  s_add_u32 m0, s35, 19456
  s_mul_i32 s56, s96, 24
  s_add_u32 s56, s56, s67
  buffer_load_dwordx4 v156, s[4:7], s56 offen sc1 lds
  s_add_u32 m0, s35, 38912
  s_mul_i32 s56, s96, 56
  s_add_u32 s56, s56, s67
  buffer_load_dwordx4 v156, s[4:7], s56 offen sc1 lds
  s_add_u32 m0, s97, 161456
  s_mov_b64 exec, 1
  buffer_load_dword v0, s[12:15], 0 offen lds
  s_mov_b64 exec, -1
  s_waitcnt vmcnt(11)
  v_add_f32 v56, v56, v60
  v_add_f32 v57, v57, v61
  v_add_f32 v58, v58, v62
  v_add_f32 v59, v59, v63
  v_add_f32 v56, v56, v64
  v_add_f32 v57, v57, v65
  v_add_f32 v58, v58, v66
  v_add_f32 v59, v59, v67
  v_add_f32 v56, v56, v68
  v_add_f32 v57, v57, v69
  v_add_f32 v58, v58, v70
  v_add_f32 v59, v59, v71
  v_add_f32 v56, v56, v72
  v_add_f32 v57, v57, v73
  v_add_f32 v58, v58, v74
  v_add_f32 v59, v59, v75
  v_add_f32 v56, v56, v76
  v_add_f32 v57, v57, v77
  v_add_f32 v58, v58, v78
  v_add_f32 v59, v59, v79
  v_add_f32 v56, v56, v80
  v_add_f32 v57, v57, v81
  v_add_f32 v58, v58, v82
  v_add_f32 v59, v59, v83
  v_add_f32 v56, v56, v84
  v_add_f32 v57, v57, v85
  v_add_f32 v58, v58, v86
  v_add_f32 v59, v59, v87
  v_add_u32 v2, 98304, v166
  ds_write_b128 v2, v[56:59]
  s_waitcnt lgkmcnt(0)
  v_mov_b32 v2, 160768
  v_mov_b32 v3, 1
  s_mov_b64 exec, 1
  ds_add_u32 v2, v3
  s_mov_b64 exec, -1
  s_mov_b32 s61, 1048576
concat_heads__linear_kernel_hedgehog__softmax_full_mha__prompt_kernel_gb_26:
  ds_read_b32 v3, v2
  s_sub_u32 s61, s61, 1
  s_waitcnt lgkmcnt(0)
  s_cbranch_scc1 concat_heads__linear_kernel_hedgehog__softmax_full_mha__prompt_kernel_gb_26x
  v_cmp_gt_u32 vcc, 12, v3
  s_cbranch_vccz concat_heads__linear_kernel_hedgehog__softmax_full_mha__prompt_kernel_gb_26x
  s_branch concat_heads__linear_kernel_hedgehog__softmax_full_mha__prompt_kernel_gb_26
concat_heads__linear_kernel_hedgehog__softmax_full_mha__prompt_kernel_gb_26x:
  v_add_u32 v2, 98304, v167
  ds_read_b128 v[88:91], v2 offset:0
  ds_read_b128 v[92:95], v2 offset:16
  ds_read_b128 v[96:99], v2 offset:32
  ds_read_b128 v[100:103], v2 offset:48
  ds_read_b128 v[104:107], v2 offset:64
  s_waitcnt lgkmcnt(0)
  v_mov_b32 v2, 160768
  v_mov_b32 v3, 1
  s_mov_b64 exec, 1
  ds_add_u32 v2, v3
  s_mov_b64 exec, -1
  s_mov_b32 s61, 1048576
concat_heads__linear_kernel_hedgehog__softmax_full_mha__prompt_kernel_gb_27:
  ds_read_b32 v3, v2
  s_sub_u32 s61, s61, 1
  s_waitcnt lgkmcnt(0)
  s_cbranch_scc1 concat_heads__linear_kernel_hedgehog__softmax_full_mha__prompt_kernel_gb_27x
  v_cmp_gt_u32 vcc, 16, v3
  s_cbranch_vccz concat_heads__linear_kernel_hedgehog__softmax_full_mha__prompt_kernel_gb_27x
  s_branch concat_heads__linear_kernel_hedgehog__softmax_full_mha__prompt_kernel_gb_27
concat_heads__linear_kernel_hedgehog__softmax_full_mha__prompt_kernel_gb_27x:
  v_cvt_pk_bf16_f32 v108, v88, v89
  v_cvt_pk_bf16_f32 v109, v90, v91
  v_cvt_pk_bf16_f32 v110, v92, v93
  v_cvt_pk_bf16_f32 v111, v94, v95
  v_cvt_pk_bf16_f32 v112, v96, v97
  v_cvt_pk_bf16_f32 v113, v98, v99
  v_cvt_pk_bf16_f32 v114, v100, v101
  v_cvt_pk_bf16_f32 v115, v102, v103
  v_cvt_pk_bf16_f32 v116, v104, v105
  v_mov_b32 v117, 0
  v_mfma_f32_32x32x16_bf16 v[56:71], v[108:111], v[16:19], 0
  v_mfma_f32_32x32x16_bf16 v[72:87], v[108:111], v[36:39], 0
  v_mfma_f32_32x32x16_bf16 v[56:71], v[112:115], v[20:23], v[56:71]
  v_mfma_f32_32x32x16_bf16 v[72:87], v[112:115], v[40:43], v[72:87]
  v_mfma_f32_32x32x8_bf16 v[56:71], v[116:117], v[24:25], v[56:71]
  v_mfma_f32_32x32x8_bf16 v[72:87], v[116:117], v[44:45], v[72:87]
  s_nop 10
  v_mov_b32 v67, v66
  v_mov_b32 v83, v82
  s_nop 0
  v_permlane32_swap_b32 v66, v67
  v_permlane32_swap_b32 v82, v83
  v_add_f32 v66, 897988541, v66
  v_add_f32 v82, 897988541, v82
  v_rcp_f32 v66, v66
  v_rcp_f32 v82, v82
  v_mul_f32 v56, v56, v66
  v_mul_f32 v57, v57, v66
  v_mul_f32 v72, v72, v82
  v_mul_f32 v73, v73, v82
  v_mul_f32 v58, v58, v66
  v_mul_f32 v59, v59, v66
  v_mul_f32 v74, v74, v82
  v_mul_f32 v75, v75, v82
  v_mul_f32 v60, v60, v66
  v_mul_f32 v61, v61, v66
  v_mul_f32 v76, v76, v82
  v_mul_f32 v77, v77, v82
  v_mul_f32 v62, v62, v66
  v_mul_f32 v63, v63, v66
  v_mul_f32 v78, v78, v82
  v_mul_f32 v79, v79, v82
  v_mul_f32 v64, v64, v66
  v_mul_f32 v65, v65, v66
  v_mul_f32 v80, v80, v82
  v_mul_f32 v81, v81, v82
  v_cvt_pk_bf16_f32 v120, v56, v57
  v_cvt_pk_bf16_f32 v121, v58, v59
  v_cvt_pk_bf16_f32 v122, v60, v61
  v_cvt_pk_bf16_f32 v123, v62, v63
  v_cvt_pk_bf16_f32 v124, v64, v65
  s_lshl_b32 s56, s65, 5
  s_add_u32 s56, s56, s32
  s_lshl_b32 s57, s56, 10
  s_add_u32 s57, s57, 16777216
  buffer_store_dwordx4 v[120:123], v1, s[4:7], s57 offen sc1
  s_lshl_b32 s56, s56, 7
  s_add_u32 s56, s56, 18874368
  s_mov_b32 exec_hi, 0
  buffer_store_dword v124, v11, s[4:7], s56 offen sc1
  s_mov_b64 exec, -1
  v_cvt_pk_bf16_f32 v128, v72, v73
  v_cvt_pk_bf16_f32 v129, v74, v75
  v_cvt_pk_bf16_f32 v130, v76, v77
  v_cvt_pk_bf16_f32 v131, v78, v79
  v_cvt_pk_bf16_f32 v132, v80, v81
  s_lshl_b32 s56, s65, 5
  s_add_u32 s56, s56, s32
  s_lshl_b32 s57, s56, 10
  s_add_u32 s57, s57, 16809984
  buffer_store_dwordx4 v[128:131], v1, s[4:7], s57 offen sc1
  s_lshl_b32 s56, s56, 7
  s_add_u32 s56, s56, 18878464
  s_mov_b32 exec_hi, 0
  buffer_store_dword v132, v11, s[4:7], s56 offen sc1
  s_mov_b64 exec, -1
  s_lshl_b32 s56, s33, 2
  s_and_b32 s57, s24, 3
  s_add_u32 s56, s56, s57
  s_lshl_b32 s56, s56, 5
  s_add_u32 s56, s56, s32
  s_lshl_b32 s56, s56, 7
  s_add_u32 s56, s56, 27656192
  s_waitcnt vmcnt(0)
  v_mov_b32 v136, s25
  v_mov_b32 v137, s26
  v_mov_b32 v138, s25
  v_mov_b32 v139, s26
  s_mov_b64 exec, 0xff
  buffer_store_dwordx4 v[136:139], v1, s[4:7], s56 offen sc1
  s_mov_b64 exec, -1
  s_nop 0
  s_lshl_b32 s57, s24, 10
  s_add_u32 m0, s57, 77824
  s_add_u32 s56, s3, 0
  buffer_load_dwordx4 v160, s[8:11], s56 offen lds
  s_lshl_b32 s57, s24, 10
  s_add_u32 m0, s57, 81920
  s_add_u32 s56, s3, 0
  buffer_load_dwordx4 v161, s[8:11], s56 offen lds
  s_lshl_b32 s57, s24, 10
  s_add_u32 m0, s57, 87040
  s_add_u32 s56, s3, 82944
  buffer_load_dwordx4 v160, s[8:11], s56 offen lds
  s_lshl_b32 s57, s24, 10
  s_add_u32 m0, s57, 91136
  s_add_u32 s56, s3, 82944
  buffer_load_dwordx4 v161, s[8:11], s56 offen lds
  s_lshl_b32 s57, s24, 10
  s_add_u32 m0, s57, 96256
  s_add_u32 s56, s3, 165888
  buffer_load_dwordx4 v160, s[8:11], s56 offen lds
  s_lshl_b32 s57, s24, 10
  s_add_u32 m0, s57, 100352
  s_add_u32 s56, s3, 165888
  buffer_load_dwordx4 v161, s[8:11], s56 offen lds
  s_lshl_b32 s57, s24, 10
  s_add_u32 m0, s57, 105472
  s_add_u32 s56, s3, 248832
  buffer_load_dwordx4 v160, s[8:11], s56 offen lds
  s_lshl_b32 s57, s24, 10
  s_add_u32 m0, s57, 109568
  s_add_u32 s56, s3, 248832
  buffer_load_dwordx4 v161, s[8:11], s56 offen lds
  s_sub_u32 s57, s24, 0
  s_lshl_b32 s57, s57, 2
  s_lshr_b32 s56, 12816, s57
  s_and_b32 s56, s56, 15
  s_mul_i32 s56, s56, 9216
  s_add_u32 m0, s56, 86016
  s_lshr_b32 s56, 12816, s57
  s_and_b32 s56, s56, 15
  s_mul_i32 s56, s56, 82944
  s_add_u32 s56, s56, s3
  buffer_load_dwordx4 v162, s[8:11], s56 offen lds
  s_and_b32 s56, s24, 3
  s_lshl_b32 s57, s56, 12
  s_add_u32 s57, s57, 87040
  v_add_u32 v13, s57, v1
  s_xor_b32 s56, s56, 2
  s_lshl_b32 s57, s56, 12
  s_add_u32 s57, s57, 87040
  v_add_u32 v12, s57, v1
  s_and_b32 s56, s56, 1
  s_lshl_b32 s56, s56, 10
  s_add_u32 s56, s56, 103424
  v_add_u32 v7, s56, v1
  s_mov_b32 s16, s50
  s_mov_b32 s17, s51
  s_mov_b32 s18, 4718592
  s_mov_b32 s19, 0x20000
  v_and_b32 v14, 19, v9
  v_lshrrev_b32 v15, 1, v9
  v_and_b32 v15, 4, v15
  v_or_b32 v14, v14, v15
  v_lshlrev_b32 v15, 1, v9
  v_and_b32 v15, 8, v15
  v_or_b32 v14, v14, v15
  s_lshl_b32 s56, s32, 1
  s_and_b32 s57, s24, 1
  s_add_u32 s56, s56, s57
  s_lshl_b32 s56, s56, 5
  v_add_u32 v14, s56, v14
  v_mul_u32_u24 v14, 2304, v14
  v_lshl_add_u32 v15, v8, 3, v14
  v_lshl_add_u32 v14, v8, 4, v14
  v_bfe_u32 v2, v0, 4, 1
  v_mul_u32_u24 v2, 36832, v2
  v_sub_u32 v14, v14, v2
  s_and_b32 s56, s32, 3
  s_lshl_b32 s56, s56, 2
  s_add_u32 s56, s56, s24
  s_mul_i32 s56, s56, 41472
  s_add_u32 s56, s56, s3
  v_min_u32 v2, 35, v0
  v_mul_u32_u24 v2, 1152, v2
  buffer_load_dword v158, v2, s[20:23], s56 offen
  buffer_load_dword v159, v2, s[20:23], s56 offen offset:140
  s_waitcnt vmcnt(0)
  s_lshl_b32 s56, s32, 12
  s_add_u32 s56, s56, 27656192
  v_lshl_add_u32 v140, v9, 7, s56
  s_lshl_b32 s56, s32, 1
  s_and_b32 s57, s24, 1
  s_add_u32 s56, s56, s57
  s_lshl_b32 s56, s56, 5
  s_bfe_u32 s57, s24, 65537
  s_lshl_b32 s57, s57, 4
  s_add_u32 s56, s56, s57
  s_lshl_b32 s59, s56, 10
  s_add_u32 s59, s59, 16777216
  s_lshl_b32 s60, s56, 7
  s_add_u32 s60, s60, 18874368
  v_lshlrev_b32 v6, 2, v9
  v_lshl_add_u32 v6, v8, 9, v6
  s_cmp_eq_u32 s24, 0
  s_cbranch_scc0 concat_heads__linear_kernel_hedgehog__softmax_full_mha__prompt_kernel_npa
  buffer_load_dwordx2 v[138:139], v140, s[4:7], 0 offen sc1
  s_waitcnt vmcnt(0)
  s_mov_b32 s61, 1048576
concat_heads__linear_kernel_hedgehog__softmax_full_mha__prompt_kernel_plp_29:
  v_cmp_eq_u32 vcc, s25, v138
  v_cmp_eq_u32 s[94:95], s26, v139
  s_and_b64 vcc, vcc, s[94:95]
  s_cmp_eq_u64 vcc, -1
  s_cbranch_scc1 concat_heads__linear_kernel_hedgehog__softmax_full_mha__prompt_kernel_pok_28
  s_sub_u32 s61, s61, 1
  s_cbranch_scc1 concat_heads__linear_kernel_hedgehog__softmax_full_mha__prompt_kernel_pok_28
  s_sleep 4
  buffer_load_dwordx2 v[138:139], v140, s[4:7], 0 offen sc1
  s_waitcnt vmcnt(0)
  s_branch concat_heads__linear_kernel_hedgehog__softmax_full_mha__prompt_kernel_plp_29
concat_heads__linear_kernel_hedgehog__softmax_full_mha__prompt_kernel_pok_28:
concat_heads__linear_kernel_hedgehog__softmax_full_mha__prompt_kernel_npa:
  v_mov_b32 v2, 160768
  v_mov_b32 v3, 1
  s_mov_b64 exec, 1
  ds_add_u32 v2, v3
  s_mov_b64 exec, -1
  s_mov_b32 s61, 1048576
concat_heads__linear_kernel_hedgehog__softmax_full_mha__prompt_kernel_gb_30:
  ds_read_b32 v3, v2
  s_sub_u32 s61, s61, 1
  s_waitcnt lgkmcnt(0)
  s_cbranch_scc1 concat_heads__linear_kernel_hedgehog__softmax_full_mha__prompt_kernel_gb_30x
  v_cmp_gt_u32 vcc, 20, v3
  s_cbranch_vccz concat_heads__linear_kernel_hedgehog__softmax_full_mha__prompt_kernel_gb_30x
  s_branch concat_heads__linear_kernel_hedgehog__softmax_full_mha__prompt_kernel_gb_30
concat_heads__linear_kernel_hedgehog__softmax_full_mha__prompt_kernel_gb_30x:
  s_or_b32 s56, s2, s24
  s_cbranch_scc1 concat_heads__linear_kernel_hedgehog__softmax_full_mha__prompt_kernel_noep
  s_mov_b32 s56, 27918336
  v_mov_b32 v136, s25
  v_mov_b32 v137, s26
  v_mov_b32 v138, s25
  v_mov_b32 v139, s26
  s_mov_b64 exec, 0xff
  buffer_store_dwordx4 v[136:139], v1, s[4:7], s56 offen sc1
  s_mov_b64 exec, -1
  s_nop 0
concat_heads__linear_kernel_hedgehog__softmax_full_mha__prompt_kernel_noep:
  buffer_load_dwordx4 v[16:19], v1, s[4:7], s59 offen offset:0 sc1
  buffer_load_dwordx4 v[20:23], v1, s[4:7], s59 offen offset:1024 sc1
  buffer_load_dwordx4 v[24:27], v1, s[4:7], s59 offen offset:2048 sc1
  buffer_load_dwordx4 v[28:31], v1, s[4:7], s59 offen offset:3072 sc1
  s_add_u32 s59, s59, 4096
  buffer_load_dwordx4 v[32:35], v1, s[4:7], s59 offen offset:0 sc1
  buffer_load_dwordx4 v[36:39], v1, s[4:7], s59 offen offset:1024 sc1
  buffer_load_dwordx4 v[40:43], v1, s[4:7], s59 offen offset:2048 sc1
  buffer_load_dwordx4 v[44:47], v1, s[4:7], s59 offen offset:3072 sc1
  s_add_u32 s59, s59, 4096
  buffer_load_dwordx4 v[48:51], v1, s[4:7], s59 offen offset:0 sc1
  buffer_load_dwordx4 v[52:55], v1, s[4:7], s59 offen offset:1024 sc1
  buffer_load_dwordx4 v[56:59], v1, s[4:7], s59 offen offset:2048 sc1
  buffer_load_dwordx4 v[60:63], v1, s[4:7], s59 offen offset:3072 sc1
  s_add_u32 s59, s59, 4096
  buffer_load_dwordx4 v[64:67], v1, s[4:7], s59 offen offset:0 sc1
  buffer_load_dwordx4 v[68:71], v1, s[4:7], s59 offen offset:1024 sc1
  buffer_load_dwordx4 v[72:75], v1, s[4:7], s59 offen offset:2048 sc1
  buffer_load_dwordx4 v[76:79], v1, s[4:7], s59 offen offset:3072 sc1
  buffer_load_dword v80, v6, s[4:7], s60 offen offset:0 sc1
  buffer_load_dword v81, v6, s[4:7], s60 offen offset:128 sc1
  buffer_load_dword v82, v6, s[4:7], s60 offen offset:256 sc1
  buffer_load_dword v83, v6, s[4:7], s60 offen offset:384 sc1
  buffer_load_dword v84, v6, s[4:7], s60 offen offset:1024 sc1
  buffer_load_dword v85, v6, s[4:7], s60 offen offset:1152 sc1
  buffer_load_dword v86, v6, s[4:7], s60 offen offset:1280 sc1
  buffer_load_dword v87, v6, s[4:7], s60 offen offset:1408 sc1
  v_bfe_u32 v4, v0, 2, 2
  v_lshl_add_u32 v4, v4, 1, v8
  v_mul_u32_u24 v4, 288, v4
  v_and_b32 v3, 3, v0
  v_lshl_add_u32 v4, v3, 3, v4
  v_bfe_u32 v3, v0, 4, 1
  v_lshl_add_u32 v4, v3, 5, v4
  s_bitcmp1_b32 s24, 1
  s_cselect_b32 s56, 36864, 0
  s_cselect_b32 s57, 4608, 0
  s_add_u32 s56, s56, 77824
  s_add_u32 s57, s57, 151552
  v_add_u32 v5, s57, v4
  v_add_u32 v4, s56, v4
  ds_read_b64_tr_b16 v[136:137], v4 offset:0
  ds_read_b64_tr_b16 v[138:139], v4 offset:144
  ds_read_b64_tr_b16 v[140:141], v4 offset:64
  ds_read_b64_tr_b16 v[142:143], v4 offset:208
  ds_read_b64_tr_b16 v[144:145], v4 offset:128
  ds_read_b64_tr_b16 v[146:147], v4 offset:272
  s_lshl_b32 s56, s32, 12
  s_add_u32 s56, s56, 27787264
  v_lshl_add_u32 v166, v9, 7, s56
  s_bfe_u32 s57, s24, 65537
  s_lshl_b32 s57, s57, 11
  s_add_u32 s56, s56, s57
  v_and_b32 v166, 15, v0
  v_lshl_add_u32 v166, v166, 7, s56
  v_and_b32 v2, 7, v0
  v_lshlrev_b32 v2, 2, v2
  v_add_u32 v2, 161584, v2
  s_mov_b32 s61, 1048576
concat_heads__linear_kernel_hedgehog__softmax_full_mha__prompt_kernel_gb_31:
  ds_read_b32 v3, v2
  s_sub_u32 s61, s61, 1
  s_waitcnt lgkmcnt(0)
  s_cbranch_scc1 concat_heads__linear_kernel_hedgehog__softmax_full_mha__prompt_kernel_gb_31x
  v_cmp_ne_u32 vcc, 0, v3
  s_cbranch_vccz concat_heads__linear_kernel_hedgehog__softmax_full_mha__prompt_kernel_gb_31x
  s_sleep 2
  s_branch concat_heads__linear_kernel_hedgehog__softmax_full_mha__prompt_kernel_gb_31
concat_heads__linear_kernel_hedgehog__softmax_full_mha__prompt_kernel_gb_31x:
  s_lshl_b32 s57, s24, 10
  s_add_u32 m0, s57, 0
  s_add_u32 s56, s3, 0
  buffer_load_dwordx4 v160, s[20:23], s56 offen lds
  s_lshl_b32 s57, s24, 10
  s_add_u32 m0, s57, 4096
  s_add_u32 s56, s3, 0
  buffer_load_dwordx4 v161, s[20:23], s56 offen lds
  s_lshl_b32 s57, s24, 10
  s_add_u32 m0, s57, 9216
  s_add_u32 s56, s3, 331776
  buffer_load_dwordx4 v160, s[20:23], s56 offen lds
  s_lshl_b32 s57, s24, 10
  s_add_u32 m0, s57, 13312
  s_add_u32 s56, s3, 331776
  buffer_load_dwordx4 v161, s[20:23], s56 offen lds
  s_lshl_b32 s57, s24, 10
  s_add_u32 m0, s57, 18432
  s_add_u32 s56, s3, 82944
  buffer_load_dwordx4 v160, s[20:23], s56 offen lds
  s_lshl_b32 s57, s24, 10
  s_add_u32 m0, s57, 22528
  s_add_u32 s56, s3, 82944
  buffer_load_dwordx4 v161, s[20:23], s56 offen lds
  s_lshl_b32 s57, s24, 10
  s_add_u32 m0, s57, 27648
  s_add_u32 s56, s3, 414720
  buffer_load_dwordx4 v160, s[20:23], s56 offen lds
  s_lshl_b32 s57, s24, 10
  s_add_u32 m0, s57, 31744
  s_add_u32 s56, s3, 414720
  buffer_load_dwordx4 v161, s[20:23], s56 offen lds
  s_sub_u32 s57, s24, 0
  s_lshl_b32 s57, s57, 2
  s_lshr_b32 s56, 12816, s57
  s_and_b32 s56, s56, 15
  s_mul_i32 s56, s56, 9216
  s_add_u32 m0, s56, 8192
  s_lshr_b32 s56, 20800, s57
  s_and_b32 s56, s56, 15
  s_mul_i32 s56, s56, 82944
  s_add_u32 s56, s56, s3
  buffer_load_dwordx4 v162, s[20:23], s56 offen lds
  s_waitcnt vmcnt(9)
  v_and_b32 v2, 7, v0
  v_lshlrev_b32 v2, 2, v2
  v_add_u32 v2, 161648, v2
  s_mov_b32 s61, 1048576
concat_heads__linear_kernel_hedgehog__softmax_full_mha__prompt_kernel_gb_32:
  ds_read_b32 v3, v2
  s_sub_u32 s61, s61, 1
  s_waitcnt lgkmcnt(0)
  s_cbranch_scc1 concat_heads__linear_kernel_hedgehog__softmax_full_mha__prompt_kernel_gb_32x
  v_cmp_ne_u32 vcc, 0, v3
  s_cbranch_vccz concat_heads__linear_kernel_hedgehog__softmax_full_mha__prompt_kernel_gb_32x
  s_sleep 2
  s_branch concat_heads__linear_kernel_hedgehog__softmax_full_mha__prompt_kernel_gb_32
concat_heads__linear_kernel_hedgehog__softmax_full_mha__prompt_kernel_gb_32x:
  s_setprio 1
  s_waitcnt lgkmcnt(0)
  v_mfma_f32_32x32x16_bf16 v[88:103], v[136:139], v[16:19], 0
  ds_read_b64_tr_b16 v[148:149], v4 offset:2304
  ds_read_b64_tr_b16 v[150:151], v4 offset:2448
  ds_read_b64_tr_b16 v[152:153], v4 offset:2368
  ds_read_b64_tr_b16 v[154:155], v4 offset:2512
  ds_read_b64_tr_b16 v[156:157], v4 offset:2432
  ds_read_b64_tr_b16 v[158:159], v4 offset:2576
  v_mfma_f32_32x32x16_bf16 v[104:119], v[140:143], v[16:19], 0
  v_mfma_f32_32x32x16_bf16 v[120:135], v[144:147], v[16:19], 0
  s_waitcnt lgkmcnt(0)
  v_mfma_f32_32x32x16_bf16 v[88:103], v[148:151], v[20:23], v[88:103]
  ds_read_b64_tr_b16 v[136:137], v4 offset:4608
  ds_read_b64_tr_b16 v[138:139], v4 offset:4752
  ds_read_b64_tr_b16 v[140:141], v4 offset:4672
  ds_read_b64_tr_b16 v[142:143], v4 offset:4816
  ds_read_b64_tr_b16 v[144:145], v4 offset:4736
  ds_read_b64_tr_b16 v[146:147], v4 offset:4880
  v_mfma_f32_32x32x16_bf16 v[104:119], v[152:155], v[20:23], v[104:119]
  v_mfma_f32_32x32x16_bf16 v[120:135], v[156:159], v[20:23], v[120:135]
  s_waitcnt lgkmcnt(0)
  v_mfma_f32_32x32x16_bf16 v[88:103], v[136:139], v[24:27], v[88:103]
  ds_read_b64_tr_b16 v[148:149], v4 offset:6912
  ds_read_b64_tr_b16 v[150:151], v4 offset:7056
  ds_read_b64_tr_b16 v[152:153], v4 offset:6976
  ds_read_b64_tr_b16 v[154:155], v4 offset:7120
  ds_read_b64_tr_b16 v[156:157], v4 offset:7040
  ds_read_b64_tr_b16 v[158:159], v4 offset:7184
  v_mfma_f32_32x32x16_bf16 v[104:119], v[140:143], v[24:27], v[104:119]
  v_mfma_f32_32x32x16_bf16 v[120:135], v[144:147], v[24:27], v[120:135]
  s_waitcnt lgkmcnt(0)
  v_mfma_f32_32x32x16_bf16 v[88:103], v[148:151], v[28:31], v[88:103]
  ds_read_b64_tr_b16 v[136:137], v4 offset:9216
  ds_read_b64_tr_b16 v[138:139], v4 offset:9360
  ds_read_b64_tr_b16 v[140:141], v4 offset:9280
  ds_read_b64_tr_b16 v[142:143], v4 offset:9424
  ds_read_b64_tr_b16 v[144:145], v4 offset:9344
  ds_read_b64_tr_b16 v[146:147], v4 offset:9488
  v_mfma_f32_32x32x16_bf16 v[104:119], v[152:155], v[28:31], v[104:119]
  v_mfma_f32_32x32x16_bf16 v[120:135], v[156:159], v[28:31], v[120:135]
  s_waitcnt lgkmcnt(0)
  v_mfma_f32_32x32x16_bf16 v[88:103], v[136:139], v[32:35], v[88:103]
  ds_read_b64_tr_b16 v[148:149], v4 offset:11520
  ds_read_b64_tr_b16 v[150:151], v4 offset:11664
  ds_read_b64_tr_b16 v[152:153], v4 offset:11584
  ds_read_b64_tr_b16 v[154:155], v4 offset:11728
  ds_read_b64_tr_b16 v[156:157], v4 offset:11648
  ds_read_b64_tr_b16 v[158:159], v4 offset:11792
  v_mfma_f32_32x32x16_bf16 v[104:119], v[140:143], v[32:35], v[104:119]
  v_mfma_f32_32x32x16_bf16 v[120:135], v[144:147], v[32:35], v[120:135]
  v_and_b32 v2, 3, v0
  v_lshlrev_b32 v2, 2, v2
  v_add_u32 v2, 161680, v2
  s_mov_b32 s61, 1048576
concat_heads__linear_kernel_hedgehog__softmax_full_mha__prompt_kernel_gb_33:
  ds_read_b32 v3, v2
  s_sub_u32 s61, s61, 1
  s_waitcnt lgkmcnt(0)
  s_cbranch_scc1 concat_heads__linear_kernel_hedgehog__softmax_full_mha__prompt_kernel_gb_33x
  v_cmp_ne_u32 vcc, 0, v3
  s_cbranch_vccz concat_heads__linear_kernel_hedgehog__softmax_full_mha__prompt_kernel_gb_33x
  s_sleep 2
  s_branch concat_heads__linear_kernel_hedgehog__softmax_full_mha__prompt_kernel_gb_33
concat_heads__linear_kernel_hedgehog__softmax_full_mha__prompt_kernel_gb_33x:
  s_waitcnt lgkmcnt(0)
  v_mfma_f32_32x32x16_bf16 v[88:103], v[148:151], v[36:39], v[88:103]
  ds_read_b64_tr_b16 v[136:137], v4 offset:13824
  ds_read_b64_tr_b16 v[138:139], v4 offset:13968
  ds_read_b64_tr_b16 v[140:141], v4 offset:13888
  ds_read_b64_tr_b16 v[142:143], v4 offset:14032
  ds_read_b64_tr_b16 v[144:145], v4 offset:13952
  ds_read_b64_tr_b16 v[146:147], v4 offset:14096
  v_mfma_f32_32x32x16_bf16 v[104:119], v[152:155], v[36:39], v[104:119]
  v_mfma_f32_32x32x16_bf16 v[120:135], v[156:159], v[36:39], v[120:135]
  s_waitcnt lgkmcnt(0)
  v_mfma_f32_32x32x16_bf16 v[88:103], v[136:139], v[40:43], v[88:103]
  ds_read_b64_tr_b16 v[148:149], v4 offset:16128
  ds_read_b64_tr_b16 v[150:151], v4 offset:16272
  ds_read_b64_tr_b16 v[152:153], v4 offset:16192
  ds_read_b64_tr_b16 v[154:155], v4 offset:16336
  ds_read_b64_tr_b16 v[156:157], v4 offset:16256
  ds_read_b64_tr_b16 v[158:159], v4 offset:16400
  v_mfma_f32_32x32x16_bf16 v[104:119], v[140:143], v[40:43], v[104:119]
  s_lshl_b32 s57, s24, 10
  s_add_u32 m0, s57, 36864
  s_add_u32 s56, s3, 165888
  buffer_load_dwordx4 v160, s[20:23], s56 offen lds
  v_mfma_f32_32x32x16_bf16 v[120:135], v[144:147], v[40:43], v[120:135]
  s_waitcnt lgkmcnt(0)
  v_mfma_f32_32x32x16_bf16 v[88:103], v[148:151], v[44:47], v[88:103]
  ds_read_b64_tr_b16 v[136:137], v4 offset:18432
  ds_read_b64_tr_b16 v[138:139], v4 offset:18576
  ds_read_b64_tr_b16 v[140:141], v4 offset:18496
  ds_read_b64_tr_b16 v[142:143], v4 offset:18640
  ds_read_b64_tr_b16 v[144:145], v4 offset:18560
  ds_read_b64_tr_b16 v[146:147], v4 offset:18704
  v_mfma_f32_32x32x16_bf16 v[104:119], v[152:155], v[44:47], v[104:119]
  s_lshl_b32 s57, s24, 10
  s_add_u32 m0, s57, 40960
  s_add_u32 s56, s3, 165888
  buffer_load_dwordx4 v161, s[20:23], s56 offen lds
  v_mfma_f32_32x32x16_bf16 v[120:135], v[156:159], v[44:47], v[120:135]
  s_waitcnt lgkmcnt(0)
  v_mfma_f32_32x32x16_bf16 v[88:103], v[136:139], v[48:51], v[88:103]
  ds_read_b64_tr_b16 v[148:149], v4 offset:20736
  ds_read_b64_tr_b16 v[150:151], v4 offset:20880
  ds_read_b64_tr_b16 v[152:153], v4 offset:20800
  ds_read_b64_tr_b16 v[154:155], v4 offset:20944
  ds_read_b64_tr_b16 v[156:157], v4 offset:20864
  ds_read_b64_tr_b16 v[158:159], v4 offset:21008
  v_mfma_f32_32x32x16_bf16 v[104:119], v[140:143], v[48:51], v[104:119]
  v_mfma_f32_32x32x16_bf16 v[120:135], v[144:147], v[48:51], v[120:135]
  s_waitcnt lgkmcnt(0)
  v_mfma_f32_32x32x16_bf16 v[88:103], v[148:151], v[52:55], v[88:103]
  ds_read_b64_tr_b16 v[136:137], v4 offset:23040
  ds_read_b64_tr_b16 v[138:139], v4 offset:23184
  ds_read_b64_tr_b16 v[140:141], v4 offset:23104
  ds_read_b64_tr_b16 v[142:143], v4 offset:23248
  ds_read_b64_tr_b16 v[144:145], v4 offset:23168
  ds_read_b64_tr_b16 v[146:147], v4 offset:23312
  v_mfma_f32_32x32x16_bf16 v[104:119], v[152:155], v[52:55], v[104:119]
  s_lshl_b32 s57, s24, 10
  s_add_u32 m0, s57, 46080
  s_add_u32 s56, s3, 497664
  buffer_load_dwordx4 v160, s[20:23], s56 offen lds
  v_mfma_f32_32x32x16_bf16 v[120:135], v[156:159], v[52:55], v[120:135]
  s_waitcnt lgkmcnt(0)
  v_mfma_f32_32x32x16_bf16 v[88:103], v[136:139], v[56:59], v[88:103]
  ds_read_b64_tr_b16 v[148:149], v4 offset:25344
  ds_read_b64_tr_b16 v[150:151], v4 offset:25488
  ds_read_b64_tr_b16 v[152:153], v4 offset:25408
  ds_read_b64_tr_b16 v[154:155], v4 offset:25552
  ds_read_b64_tr_b16 v[156:157], v4 offset:25472
  ds_read_b64_tr_b16 v[158:159], v4 offset:25616
  v_mfma_f32_32x32x16_bf16 v[104:119], v[140:143], v[56:59], v[104:119]
  s_lshl_b32 s57, s24, 10
  s_add_u32 m0, s57, 50176
  s_add_u32 s56, s3, 497664
  buffer_load_dwordx4 v161, s[20:23], s56 offen lds
  v_mfma_f32_32x32x16_bf16 v[120:135], v[144:147], v[56:59], v[120:135]
  s_waitcnt lgkmcnt(0)
  v_mfma_f32_32x32x16_bf16 v[88:103], v[148:151], v[60:63], v[88:103]
  ds_read_b64_tr_b16 v[136:137], v4 offset:27648
  ds_read_b64_tr_b16 v[138:139], v4 offset:27792
  ds_read_b64_tr_b16 v[140:141], v4 offset:27712
  ds_read_b64_tr_b16 v[142:143], v4 offset:27856
  ds_read_b64_tr_b16 v[144:145], v4 offset:27776
  ds_read_b64_tr_b16 v[146:147], v4 offset:27920
  v_mfma_f32_32x32x16_bf16 v[104:119], v[152:155], v[60:63], v[104:119]
  v_mfma_f32_32x32x16_bf16 v[120:135], v[156:159], v[60:63], v[120:135]
  s_waitcnt lgkmcnt(0)
  v_mfma_f32_32x32x16_bf16 v[88:103], v[136:139], v[64:67], v[88:103]
  ds_read_b64_tr_b16 v[148:149], v4 offset:29952
  ds_read_b64_tr_b16 v[150:151], v4 offset:30096
  ds_read_b64_tr_b16 v[152:153], v4 offset:30016
  ds_read_b64_tr_b16 v[154:155], v4 offset:30160
  ds_read_b64_tr_b16 v[156:157], v4 offset:30080
  ds_read_b64_tr_b16 v[158:159], v4 offset:30224
  v_mfma_f32_32x32x16_bf16 v[104:119], v[140:143], v[64:67], v[104:119]
  s_lshl_b32 s57, s24, 10
  s_add_u32 m0, s57, 55296
  s_add_u32 s56, s3, 248832
  buffer_load_dwordx4 v160, s[20:23], s56 offen lds
  v_mfma_f32_32x32x16_bf16 v[120:135], v[144:147], v[64:67], v[120:135]
  s_waitcnt lgkmcnt(0)
  v_mfma_f32_32x32x16_bf16 v[88:103], v[148:151], v[68:71], v[88:103]
  ds_read_b64_tr_b16 v[136:137], v4 offset:32256
  ds_read_b64_tr_b16 v[138:139], v4 offset:32400
  ds_read_b64_tr_b16 v[140:141], v4 offset:32320
  ds_read_b64_tr_b16 v[142:143], v4 offset:32464
  ds_read_b64_tr_b16 v[144:145], v4 offset:32384
  ds_read_b64_tr_b16 v[146:147], v4 offset:32528
  v_mfma_f32_32x32x16_bf16 v[104:119], v[152:155], v[68:71], v[104:119]
  s_lshl_b32 s57, s24, 10
  s_add_u32 m0, s57, 59392
  s_add_u32 s56, s3, 248832
  buffer_load_dwordx4 v161, s[20:23], s56 offen lds
  v_mfma_f32_32x32x16_bf16 v[120:135], v[156:159], v[68:71], v[120:135]
  s_waitcnt lgkmcnt(0)
  v_mfma_f32_32x32x16_bf16 v[88:103], v[136:139], v[72:75], v[88:103]
  ds_read_b64_tr_b16 v[148:149], v4 offset:34560
  ds_read_b64_tr_b16 v[150:151], v4 offset:34704
  ds_read_b64_tr_b16 v[152:153], v4 offset:34624
  ds_read_b64_tr_b16 v[154:155], v4 offset:34768
  ds_read_b64_tr_b16 v[156:157], v4 offset:34688
  ds_read_b64_tr_b16 v[158:159], v4 offset:34832
  v_mfma_f32_32x32x16_bf16 v[104:119], v[140:143], v[72:75], v[104:119]
  v_mfma_f32_32x32x16_bf16 v[120:135], v[144:147], v[72:75], v[120:135]
  s_waitcnt lgkmcnt(0)
  v_mfma_f32_32x32x16_bf16 v[88:103], v[148:151], v[76:79], v[88:103]
  ds_read_b64_tr_b16 v[136:137], v5 offset:0
  ds_read_b64_tr_b16 v[138:139], v5 offset:144
  ds_read_b64_tr_b16 v[140:141], v5 offset:64
  ds_read_b64_tr_b16 v[142:143], v5 offset:208
  ds_read_b64_tr_b16 v[144:145], v5 offset:128
  ds_read_b64_tr_b16 v[146:147], v5 offset:272
  v_mfma_f32_32x32x16_bf16 v[104:119], v[152:155], v[76:79], v[104:119]
  s_lshl_b32 s57, s24, 10
  s_add_u32 m0, s57, 64512
  s_add_u32 s56, s3, 580608
  buffer_load_dwordx4 v160, s[20:23], s56 offen lds
  v_mfma_f32_32x32x16_bf16 v[120:135], v[156:159], v[76:79], v[120:135]
  s_waitcnt lgkmcnt(0)
  v_mfma_f32_32x32x16_bf16 v[88:103], v[136:139], v[80:83], v[88:103]
  ds_read_b64_tr_b16 v[148:149], v5 offset:2304
  ds_read_b64_tr_b16 v[150:151], v5 offset:2448
  ds_read_b64_tr_b16 v[152:153], v5 offset:2368
  ds_read_b64_tr_b16 v[154:155], v5 offset:2512
  ds_read_b64_tr_b16 v[156:157], v5 offset:2432
  ds_read_b64_tr_b16 v[158:159], v5 offset:2576
  v_mfma_f32_32x32x16_bf16 v[104:119], v[140:143], v[80:83], v[104:119]
  s_lshl_b32 s57, s24, 10
  s_add_u32 m0, s57, 68608
  s_add_u32 s56, s3, 580608
  buffer_load_dwordx4 v161, s[20:23], s56 offen lds
  v_mfma_f32_32x32x16_bf16 v[120:135], v[144:147], v[80:83], v[120:135]
  s_waitcnt lgkmcnt(0)
  v_mfma_f32_32x32x16_bf16 v[88:103], v[148:151], v[84:87], v[88:103]
  v_mfma_f32_32x32x16_bf16 v[104:119], v[152:155], v[84:87], v[104:119]
  s_sub_u32 s57, s24, 0
  s_lshl_b32 s57, s57, 2
  s_lshr_b32 s56, 30292, s57
  s_and_b32 s56, s56, 15
  s_mul_i32 s56, s56, 9216
  s_add_u32 m0, s56, 8192
  s_lshr_b32 s56, 29538, s57
  s_and_b32 s56, s56, 15
  s_mul_i32 s56, s56, 82944
  s_add_u32 s56, s56, s3
  buffer_load_dwordx4 v162, s[20:23], s56 offen lds
  v_mfma_f32_32x32x16_bf16 v[120:135], v[156:159], v[84:87], v[120:135]
  v_mov_b32 v2, 160768
  v_mov_b32 v3, 1
  s_mov_b64 exec, 1
  ds_add_u32 v2, v3
  s_mov_b64 exec, -1
  s_mov_b32 s61, 1048576
concat_heads__linear_kernel_hedgehog__softmax_full_mha__prompt_kernel_gb_34:
  ds_read_b32 v3, v2
  s_sub_u32 s61, s61, 1
  s_waitcnt lgkmcnt(0)
  s_cbranch_scc1 concat_heads__linear_kernel_hedgehog__softmax_full_mha__prompt_kernel_gb_34x
  v_cmp_gt_u32 vcc, 24, v3
  s_cbranch_vccz concat_heads__linear_kernel_hedgehog__softmax_full_mha__prompt_kernel_gb_34x
  s_branch concat_heads__linear_kernel_hedgehog__softmax_full_mha__prompt_kernel_gb_34
concat_heads__linear_kernel_hedgehog__softmax_full_mha__prompt_kernel_gb_34x:
  s_bitcmp1_b32 s24, 1
  s_cbranch_scc1 concat_heads__linear_kernel_hedgehog__softmax_full_mha__prompt_kernel_rw1a
  ds_write_b128 v13, v[104:107] offset:0
  ds_write_b128 v13, v[108:111] offset:1024
  ds_write_b128 v13, v[112:115] offset:2048
  ds_write_b128 v13, v[116:119] offset:3072
  s_branch concat_heads__linear_kernel_hedgehog__softmax_full_mha__prompt_kernel_rw2a
concat_heads__linear_kernel_hedgehog__softmax_full_mha__prompt_kernel_rw1a:
  ds_write_b128 v13, v[88:91] offset:0
  ds_write_b128 v13, v[92:95] offset:1024
  ds_write_b128 v13, v[96:99] offset:2048
  ds_write_b128 v13, v[100:103] offset:3072
  ds_write_b128 v7, v[120:123]
  v_mov_b32 v88, v104
  v_mov_b32 v89, v105
  v_mov_b32 v90, v106
  v_mov_b32 v91, v107
  v_mov_b32 v92, v108
  v_mov_b32 v93, v109
  v_mov_b32 v94, v110
  v_mov_b32 v95, v111
  v_mov_b32 v96, v112
  v_mov_b32 v97, v113
  v_mov_b32 v98, v114
  v_mov_b32 v99, v115
  v_mov_b32 v100, v116
  v_mov_b32 v101, v117
  v_mov_b32 v102, v118
  v_mov_b32 v103, v119
concat_heads__linear_kernel_hedgehog__softmax_full_mha__prompt_kernel_rw2a:
  s_waitcnt lgkmcnt(0)
  s_lshl_b32 s57, s24, 10
  s_add_u32 m0, s57, 77824
  s_add_u32 s56, s3, 0
  buffer_load_dwordx4 v163, s[20:23], s56 offen lds
  s_lshl_b32 s57, s24, 10
  s_add_u32 m0, s57, 81920
  s_add_u32 s56, s3, 0
  buffer_load_dwordx4 v164, s[20:23], s56 offen lds
  s_mov_b32 m0, 86016
  s_nop 0
  buffer_load_dwordx4 v165, s[20:23], s3 offen lds
  s_lshl_b32 s56, s32, 12
  s_add_u32 s56, s56, 27787264
  v_lshl_add_u32 v140, v9, 7, s56
  s_lshl_b32 s56, s32, 1
  s_and_b32 s57, s24, 1
  s_add_u32 s56, s56, s57
  s_lshl_b32 s56, s56, 5
  s_bfe_u32 s57, s24, 65537
  s_lshl_b32 s57, s57, 4
  s_add_u32 s56, s56, s57
  s_lshl_b32 s59, s56, 10
  s_add_u32 s59, s59, 20971520
  s_lshl_b32 s60, s56, 7
  s_add_u32 s60, s60, 23068672
  v_lshlrev_b32 v6, 2, v9
  v_lshl_add_u32 v6, v8, 9, v6
  v_bfe_u32 v4, v0, 2, 2
  v_lshl_add_u32 v4, v4, 1, v8
  v_mul_u32_u24 v4, 288, v4
  v_and_b32 v3, 3, v0
  v_lshl_add_u32 v4, v3, 3, v4
  v_bfe_u32 v3, v0, 4, 1
  v_lshl_add_u32 v4, v3, 5, v4
  s_bitcmp1_b32 s24, 1
  s_cselect_b32 s56, 9216, 0
  s_cselect_b32 s57, 4608, 0
  s_add_u32 s56, s56, 0
  s_add_u32 s57, s57, 77824
  v_add_u32 v5, s57, v4
  v_add_u32 v4, s56, v4
  s_waitcnt vmcnt(3)
  v_mov_b32 v2, 160768
  v_mov_b32 v3, 1
  s_mov_b64 exec, 1
  ds_add_u32 v2, v3
  s_mov_b64 exec, -1
  s_mov_b32 s61, 1048576
concat_heads__linear_kernel_hedgehog__softmax_full_mha__prompt_kernel_gb_35:
  ds_read_b32 v3, v2
  s_sub_u32 s61, s61, 1
  s_waitcnt lgkmcnt(0)
  s_cbranch_scc1 concat_heads__linear_kernel_hedgehog__softmax_full_mha__prompt_kernel_gb_35x
  v_cmp_gt_u32 vcc, 28, v3
  s_cbranch_vccz concat_heads__linear_kernel_hedgehog__softmax_full_mha__prompt_kernel_gb_35x
  s_branch concat_heads__linear_kernel_hedgehog__softmax_full_mha__prompt_kernel_gb_35
concat_heads__linear_kernel_hedgehog__softmax_full_mha__prompt_kernel_gb_35x:
  s_mov_b32 s61, 1048576
concat_heads__linear_kernel_hedgehog__softmax_full_mha__prompt_kernel_pp:
  buffer_load_dwordx2 v[80:81], v166, s[4:7], 0 offen sc1
  s_waitcnt vmcnt(0)
  v_cmp_eq_u32 vcc, s25, v80
  v_cmp_eq_u32 s[94:95], s26, v81
  s_and_b64 vcc, vcc, s[94:95]
  s_cmp_eq_u64 vcc, -1
  s_cbranch_scc1 concat_heads__linear_kernel_hedgehog__softmax_full_mha__prompt_kernel_ppx
  s_sub_u32 s61, s61, 1
  s_cbranch_scc0 concat_heads__linear_kernel_hedgehog__softmax_full_mha__prompt_kernel_pp
concat_heads__linear_kernel_hedgehog__softmax_full_mha__prompt_kernel_ppx:
  s_add_u32 s56, s59, 0
  buffer_load_dwordx4 v[16:19], v1, s[4:7], s56 offen offset:0 sc1
  s_add_u32 s56, s59, 0
  buffer_load_dwordx4 v[20:23], v1, s[4:7], s56 offen offset:1024 sc1
  s_add_u32 s56, s59, 0
  buffer_load_dwordx4 v[24:27], v1, s[4:7], s56 offen offset:2048 sc1
  s_add_u32 s56, s59, 0
  buffer_load_dwordx4 v[28:31], v1, s[4:7], s56 offen offset:3072 sc1
  s_add_u32 s56, s59, 4096
  buffer_load_dwordx4 v[32:35], v1, s[4:7], s56 offen offset:0 sc1
  s_add_u32 s56, s59, 4096
  buffer_load_dwordx4 v[36:39], v1, s[4:7], s56 offen offset:1024 sc1
  ds_read_b128 v[136:139], v12 offset:0
  ds_read_b128 v[140:143], v12 offset:1024
  ds_read_b128 v[144:147], v12 offset:2048
  ds_read_b128 v[148:151], v12 offset:3072
  ds_read_b128 v[152:155], v7
  s_add_u32 s56, s3, 0
  s_bitcmp1_b32 s24, 1
  s_cselect_b32 s57, 64, 0
  s_add_u32 s57, s57, s56
  s_waitcnt lgkmcnt(0)
  v_add_f32 v88, v88, v136
  v_add_f32 v89, v89, v137
  v_add_f32 v90, v90, v138
  v_add_f32 v91, v91, v139
  v_add_f32 v92, v92, v140
  v_add_f32 v93, v93, v141
  v_add_f32 v94, v94, v142
  v_add_f32 v95, v95, v143
  v_add_f32 v96, v96, v144
  v_add_f32 v97, v97, v145
  v_add_f32 v98, v98, v146
  v_add_f32 v99, v99, v147
  v_add_f32 v100, v100, v148
  v_add_f32 v101, v101, v149
  v_add_f32 v102, v102, v150
  v_add_f32 v103, v103, v151
  v_cvt_pk_bf16_f32 v104, v88, v89
  v_cvt_pk_bf16_f32 v105, v90, v91
  v_cvt_pk_bf16_f32 v106, v92, v93
  v_cvt_pk_bf16_f32 v107, v94, v95
  v_cvt_pk_bf16_f32 v108, v96, v97
  v_cvt_pk_bf16_f32 v109, v98, v99
  v_cvt_pk_bf16_f32 v110, v100, v101
  v_cvt_pk_bf16_f32 v111, v102, v103
  s_nop 0
  v_permlane32_swap_b32 v104, v106
  v_permlane32_swap_b32 v105, v107
  v_permlane32_swap_b32 v108, v110
  v_permlane32_swap_b32 v109, v111
  s_nop 0
  v_permlane16_swap_b32 v104, v108
  v_permlane16_swap_b32 v105, v109
  v_permlane16_swap_b32 v106, v110
  v_permlane16_swap_b32 v107, v111
  s_bitcmp1_b32 s24, 1
  s_cbranch_scc1 concat_heads__linear_kernel_hedgehog__softmax_full_mha__prompt_kernel_rsa
  v_add_f32 v120, v120, v152
  v_add_f32 v121, v121, v153
  v_add_f32 v122, v122, v154
  v_add_f32 v123, v123, v155
  v_cvt_pk_bf16_f32 v112, v120, v121
  v_cvt_pk_bf16_f32 v113, v122, v123
  v_mov_b32 v10, v112
  v_mov_b32 v11, v113
concat_heads__linear_kernel_hedgehog__softmax_full_mha__prompt_kernel_rsa:
  v_mov_b32 v160, v104
  v_mov_b32 v161, v105
  v_mov_b32 v162, v106
  v_mov_b32 v163, v107
  v_mov_b32 v164, v108
  v_mov_b32 v165, v109
  v_mov_b32 v166, v110
  v_mov_b32 v167, v111
  ds_read_b64_tr_b16 v[136:137], v4 offset:0
  ds_read_b64_tr_b16 v[138:139], v4 offset:144
  ds_read_b64_tr_b16 v[140:141], v4 offset:64
  ds_read_b64_tr_b16 v[142:143], v4 offset:208
  ds_read_b64_tr_b16 v[144:145], v4 offset:128
  ds_read_b64_tr_b16 v[146:147], v4 offset:272
  s_waitcnt vmcnt(5) lgkmcnt(0)
  v_mfma_f32_32x32x16_bf16 v[88:103], v[136:139], v[16:19], 0
  ds_read_b64_tr_b16 v[148:149], v4 offset:2304
  ds_read_b64_tr_b16 v[150:151], v4 offset:2448
  ds_read_b64_tr_b16 v[152:153], v4 offset:2368
  ds_read_b64_tr_b16 v[154:155], v4 offset:2512
  ds_read_b64_tr_b16 v[156:157], v4 offset:2432
  ds_read_b64_tr_b16 v[158:159], v4 offset:2576
  v_mfma_f32_32x32x16_bf16 v[104:119], v[140:143], v[16:19], 0
  s_add_u32 s56, s59, 4096
  buffer_load_dwordx4 v[40:43], v1, s[4:7], s56 offen offset:2048 sc1
  v_mfma_f32_32x32x16_bf16 v[120:135], v[144:147], v[16:19], 0
  s_waitcnt vmcnt(5) lgkmcnt(0)
  v_mfma_f32_32x32x16_bf16 v[88:103], v[148:151], v[20:23], v[88:103]
  ds_read_b64_tr_b16 v[136:137], v4 offset:4608
  ds_read_b64_tr_b16 v[138:139], v4 offset:4752
  ds_read_b64_tr_b16 v[140:141], v4 offset:4672
  ds_read_b64_tr_b16 v[142:143], v4 offset:4816
  ds_read_b64_tr_b16 v[144:145], v4 offset:4736
  ds_read_b64_tr_b16 v[146:147], v4 offset:4880
  v_mfma_f32_32x32x16_bf16 v[104:119], v[152:155], v[20:23], v[104:119]
  s_add_u32 s56, s59, 4096
  buffer_load_dwordx4 v[44:47], v1, s[4:7], s56 offen offset:3072 sc1
  v_mfma_f32_32x32x16_bf16 v[120:135], v[156:159], v[20:23], v[120:135]
  s_waitcnt vmcnt(5) lgkmcnt(0)
  v_mfma_f32_32x32x16_bf16 v[88:103], v[136:139], v[24:27], v[88:103]
  ds_read_b64_tr_b16 v[148:149], v4 offset:6912
  ds_read_b64_tr_b16 v[150:151], v4 offset:7056
  ds_read_b64_tr_b16 v[152:153], v4 offset:6976
  ds_read_b64_tr_b16 v[154:155], v4 offset:7120
  ds_read_b64_tr_b16 v[156:157], v4 offset:7040
  ds_read_b64_tr_b16 v[158:159], v4 offset:7184
  v_mfma_f32_32x32x16_bf16 v[104:119], v[140:143], v[24:27], v[104:119]
  s_add_u32 s56, s59, 8192
  buffer_load_dwordx4 v[48:51], v1, s[4:7], s56 offen offset:0 sc1
  v_mfma_f32_32x32x16_bf16 v[120:135], v[144:147], v[24:27], v[120:135]
  s_waitcnt vmcnt(5) lgkmcnt(0)
  v_mfma_f32_32x32x16_bf16 v[88:103], v[148:151], v[28:31], v[88:103]
  ds_read_b64_tr_b16 v[136:137], v4 offset:18432
  ds_read_b64_tr_b16 v[138:139], v4 offset:18576
  ds_read_b64_tr_b16 v[140:141], v4 offset:18496
  ds_read_b64_tr_b16 v[142:143], v4 offset:18640
  ds_read_b64_tr_b16 v[144:145], v4 offset:18560
  ds_read_b64_tr_b16 v[146:147], v4 offset:18704
  v_mfma_f32_32x32x16_bf16 v[104:119], v[152:155], v[28:31], v[104:119]
  s_add_u32 s56, s59, 8192
  buffer_load_dwordx4 v[52:55], v1, s[4:7], s56 offen offset:1024 sc1
  v_mfma_f32_32x32x16_bf16 v[120:135], v[156:159], v[28:31], v[120:135]
  s_waitcnt vmcnt(5) lgkmcnt(0)
  v_mfma_f32_32x32x16_bf16 v[88:103], v[136:139], v[32:35], v[88:103]
  ds_read_b64_tr_b16 v[148:149], v4 offset:20736
  ds_read_b64_tr_b16 v[150:151], v4 offset:20880
  ds_read_b64_tr_b16 v[152:153], v4 offset:20800
  ds_read_b64_tr_b16 v[154:155], v4 offset:20944
  ds_read_b64_tr_b16 v[156:157], v4 offset:20864
  ds_read_b64_tr_b16 v[158:159], v4 offset:21008
  v_mfma_f32_32x32x16_bf16 v[104:119], v[140:143], v[32:35], v[104:119]
  s_add_u32 s56, s59, 8192
  buffer_load_dwordx4 v[56:59], v1, s[4:7], s56 offen offset:2048 sc1
  v_mfma_f32_32x32x16_bf16 v[120:135], v[144:147], v[32:35], v[120:135]
  s_waitcnt vmcnt(5) lgkmcnt(0)
  v_mfma_f32_32x32x16_bf16 v[88:103], v[148:151], v[36:39], v[88:103]
  ds_read_b64_tr_b16 v[136:137], v4 offset:23040
  ds_read_b64_tr_b16 v[138:139], v4 offset:23184
  ds_read_b64_tr_b16 v[140:141], v4 offset:23104
  ds_read_b64_tr_b16 v[142:143], v4 offset:23248
  ds_read_b64_tr_b16 v[144:145], v4 offset:23168
  ds_read_b64_tr_b16 v[146:147], v4 offset:23312
  v_mfma_f32_32x32x16_bf16 v[104:119], v[152:155], v[36:39], v[104:119]
  s_add_u32 s56, s59, 8192
  buffer_load_dwordx4 v[60:63], v1, s[4:7], s56 offen offset:3072 sc1
  v_mfma_f32_32x32x16_bf16 v[120:135], v[156:159], v[36:39], v[120:135]
  s_waitcnt vmcnt(5) lgkmcnt(0)
  v_mfma_f32_32x32x16_bf16 v[88:103], v[136:139], v[40:43], v[88:103]
  ds_read_b64_tr_b16 v[148:149], v4 offset:25344
  ds_read_b64_tr_b16 v[150:151], v4 offset:25488
  ds_read_b64_tr_b16 v[152:153], v4 offset:25408
  ds_read_b64_tr_b16 v[154:155], v4 offset:25552
  ds_read_b64_tr_b16 v[156:157], v4 offset:25472
  ds_read_b64_tr_b16 v[158:159], v4 offset:25616
  v_mfma_f32_32x32x16_bf16 v[104:119], v[140:143], v[40:43], v[104:119]
  s_add_u32 s56, s59, 12288
  buffer_load_dwordx4 v[64:67], v1, s[4:7], s56 offen offset:0 sc1
  v_mfma_f32_32x32x16_bf16 v[120:135], v[144:147], v[40:43], v[120:135]
  s_waitcnt vmcnt(5) lgkmcnt(0)
  v_mfma_f32_32x32x16_bf16 v[88:103], v[148:151], v[44:47], v[88:103]
  ds_read_b64_tr_b16 v[136:137], v4 offset:36864
  ds_read_b64_tr_b16 v[138:139], v4 offset:37008
  ds_read_b64_tr_b16 v[140:141], v4 offset:36928
  ds_read_b64_tr_b16 v[142:143], v4 offset:37072
  ds_read_b64_tr_b16 v[144:145], v4 offset:36992
  ds_read_b64_tr_b16 v[146:147], v4 offset:37136
  v_mfma_f32_32x32x16_bf16 v[104:119], v[152:155], v[44:47], v[104:119]
  s_add_u32 s56, s59, 12288
  buffer_load_dwordx4 v[68:71], v1, s[4:7], s56 offen offset:1024 sc1
  v_mfma_f32_32x32x16_bf16 v[120:135], v[156:159], v[44:47], v[120:135]
  s_waitcnt vmcnt(5) lgkmcnt(0)
  v_mfma_f32_32x32x16_bf16 v[88:103], v[136:139], v[48:51], v[88:103]
  ds_read_b64_tr_b16 v[148:149], v4 offset:39168
  ds_read_b64_tr_b16 v[150:151], v4 offset:39312
  ds_read_b64_tr_b16 v[152:153], v4 offset:39232
  ds_read_b64_tr_b16 v[154:155], v4 offset:39376
  ds_read_b64_tr_b16 v[156:157], v4 offset:39296
  ds_read_b64_tr_b16 v[158:159], v4 offset:39440
  v_mfma_f32_32x32x16_bf16 v[104:119], v[140:143], v[48:51], v[104:119]
  s_add_u32 s56, s59, 12288
  buffer_load_dwordx4 v[72:75], v1, s[4:7], s56 offen offset:2048 sc1
  v_mfma_f32_32x32x16_bf16 v[120:135], v[144:147], v[48:51], v[120:135]
  s_waitcnt vmcnt(5) lgkmcnt(0)
  v_mfma_f32_32x32x16_bf16 v[88:103], v[148:151], v[52:55], v[88:103]
  ds_read_b64_tr_b16 v[136:137], v4 offset:41472
  ds_read_b64_tr_b16 v[138:139], v4 offset:41616
  ds_read_b64_tr_b16 v[140:141], v4 offset:41536
  ds_read_b64_tr_b16 v[142:143], v4 offset:41680
  ds_read_b64_tr_b16 v[144:145], v4 offset:41600
  ds_read_b64_tr_b16 v[146:147], v4 offset:41744
  v_mfma_f32_32x32x16_bf16 v[104:119], v[152:155], v[52:55], v[104:119]
  s_add_u32 s56, s59, 12288
  buffer_load_dwordx4 v[76:79], v1, s[4:7], s56 offen offset:3072 sc1
  v_mfma_f32_32x32x16_bf16 v[120:135], v[156:159], v[52:55], v[120:135]
  s_waitcnt vmcnt(5) lgkmcnt(0)
  v_mfma_f32_32x32x16_bf16 v[88:103], v[136:139], v[56:59], v[88:103]
  ds_read_b64_tr_b16 v[148:149], v4 offset:43776
  ds_read_b64_tr_b16 v[150:151], v4 offset:43920
  ds_read_b64_tr_b16 v[152:153], v4 offset:43840
  ds_read_b64_tr_b16 v[154:155], v4 offset:43984
  ds_read_b64_tr_b16 v[156:157], v4 offset:43904
  ds_read_b64_tr_b16 v[158:159], v4 offset:44048
  v_mfma_f32_32x32x16_bf16 v[104:119], v[140:143], v[56:59], v[104:119]
  buffer_load_dword v80, v6, s[4:7], s60 offen offset:0 sc1
  buffer_load_dword v81, v6, s[4:7], s60 offen offset:128 sc1
  buffer_load_dword v82, v6, s[4:7], s60 offen offset:256 sc1
  buffer_load_dword v83, v6, s[4:7], s60 offen offset:384 sc1
  v_mfma_f32_32x32x16_bf16 v[120:135], v[144:147], v[56:59], v[120:135]
  s_waitcnt vmcnt(8) lgkmcnt(0)
  v_mfma_f32_32x32x16_bf16 v[88:103], v[148:151], v[60:63], v[88:103]
  ds_read_b64_tr_b16 v[136:137], v4 offset:55296
  ds_read_b64_tr_b16 v[138:139], v4 offset:55440
  ds_read_b64_tr_b16 v[140:141], v4 offset:55360
  ds_read_b64_tr_b16 v[142:143], v4 offset:55504
  ds_read_b64_tr_b16 v[144:145], v4 offset:55424
  ds_read_b64_tr_b16 v[146:147], v4 offset:55568
  v_mfma_f32_32x32x16_bf16 v[104:119], v[152:155], v[60:63], v[104:119]
  buffer_load_dword v84, v6, s[4:7], s60 offen offset:1024 sc1
  buffer_load_dword v85, v6, s[4:7], s60 offen offset:1152 sc1
  buffer_load_dword v86, v6, s[4:7], s60 offen offset:1280 sc1
  buffer_load_dword v87, v6, s[4:7], s60 offen offset:1408 sc1
  v_mfma_f32_32x32x16_bf16 v[120:135], v[156:159], v[60:63], v[120:135]
  s_waitcnt vmcnt(11) lgkmcnt(0)
  v_mfma_f32_32x32x16_bf16 v[88:103], v[136:139], v[64:67], v[88:103]
  ds_read_b64_tr_b16 v[148:149], v4 offset:57600
  ds_read_b64_tr_b16 v[150:151], v4 offset:57744
  ds_read_b64_tr_b16 v[152:153], v4 offset:57664
  ds_read_b64_tr_b16 v[154:155], v4 offset:57808
  ds_read_b64_tr_b16 v[156:157], v4 offset:57728
  ds_read_b64_tr_b16 v[158:159], v4 offset:57872
  v_mfma_f32_32x32x16_bf16 v[104:119], v[140:143], v[64:67], v[104:119]
  v_mfma_f32_32x32x16_bf16 v[120:135], v[144:147], v[64:67], v[120:135]
  s_waitcnt vmcnt(10) lgkmcnt(0)
  v_mfma_f32_32x32x16_bf16 v[88:103], v[148:151], v[68:71], v[88:103]
  ds_read_b64_tr_b16 v[136:137], v4 offset:59904
  ds_read_b64_tr_b16 v[138:139], v4 offset:60048
  ds_read_b64_tr_b16 v[140:141], v4 offset:59968
  ds_read_b64_tr_b16 v[142:143], v4 offset:60112
  ds_read_b64_tr_b16 v[144:145], v4 offset:60032
  ds_read_b64_tr_b16 v[146:147], v4 offset:60176
  v_mfma_f32_32x32x16_bf16 v[104:119], v[152:155], v[68:71], v[104:119]
  v_mfma_f32_32x32x16_bf16 v[120:135], v[156:159], v[68:71], v[120:135]
  s_waitcnt vmcnt(9) lgkmcnt(0)
  v_mfma_f32_32x32x16_bf16 v[88:103], v[136:139], v[72:75], v[88:103]
  ds_read_b64_tr_b16 v[148:149], v4 offset:62208
  ds_read_b64_tr_b16 v[150:151], v4 offset:62352
  ds_read_b64_tr_b16 v[152:153], v4 offset:62272
  ds_read_b64_tr_b16 v[154:155], v4 offset:62416
  ds_read_b64_tr_b16 v[156:157], v4 offset:62336
  ds_read_b64_tr_b16 v[158:159], v4 offset:62480
  v_mfma_f32_32x32x16_bf16 v[104:119], v[140:143], v[72:75], v[104:119]
  v_mfma_f32_32x32x16_bf16 v[120:135], v[144:147], v[72:75], v[120:135]
  s_waitcnt vmcnt(8) lgkmcnt(0)
  v_mov_b32 v2, 160768
  v_mov_b32 v3, 1
  s_mov_b64 exec, 1
  ds_add_u32 v2, v3
  s_mov_b64 exec, -1
  s_mov_b32 s61, 1048576
concat_heads__linear_kernel_hedgehog__softmax_full_mha__prompt_kernel_gb_36:
  ds_read_b32 v3, v2
  s_sub_u32 s61, s61, 1
  s_waitcnt lgkmcnt(0)
  s_cbranch_scc1 concat_heads__linear_kernel_hedgehog__softmax_full_mha__prompt_kernel_gb_36x
  v_cmp_gt_u32 vcc, 32, v3
  s_cbranch_vccz concat_heads__linear_kernel_hedgehog__softmax_full_mha__prompt_kernel_gb_36x
  s_branch concat_heads__linear_kernel_hedgehog__softmax_full_mha__prompt_kernel_gb_36
concat_heads__linear_kernel_hedgehog__softmax_full_mha__prompt_kernel_gb_36x:
  v_mfma_f32_32x32x16_bf16 v[88:103], v[148:151], v[76:79], v[88:103]
  ds_read_b64_tr_b16 v[136:137], v5 offset:0
  ds_read_b64_tr_b16 v[138:139], v5 offset:144
  ds_read_b64_tr_b16 v[140:141], v5 offset:64
  ds_read_b64_tr_b16 v[142:143], v5 offset:208
  ds_read_b64_tr_b16 v[144:145], v5 offset:128
  ds_read_b64_tr_b16 v[146:147], v5 offset:272
  v_mfma_f32_32x32x16_bf16 v[104:119], v[152:155], v[76:79], v[104:119]
  v_mfma_f32_32x32x16_bf16 v[120:135], v[156:159], v[76:79], v[120:135]
  s_waitcnt vmcnt(4) lgkmcnt(0)
  v_mfma_f32_32x32x16_bf16 v[88:103], v[136:139], v[80:83], v[88:103]
  ds_read_b64_tr_b16 v[148:149], v5 offset:2304
  ds_read_b64_tr_b16 v[150:151], v5 offset:2448
  ds_read_b64_tr_b16 v[152:153], v5 offset:2368
  ds_read_b64_tr_b16 v[154:155], v5 offset:2512
  ds_read_b64_tr_b16 v[156:157], v5 offset:2432
  ds_read_b64_tr_b16 v[158:159], v5 offset:2576
  v_mfma_f32_32x32x16_bf16 v[104:119], v[140:143], v[80:83], v[104:119]
  v_mfma_f32_32x32x16_bf16 v[120:135], v[144:147], v[80:83], v[120:135]
  s_waitcnt vmcnt(0) lgkmcnt(0)
  v_mfma_f32_32x32x16_bf16 v[88:103], v[148:151], v[84:87], v[88:103]
  v_mfma_f32_32x32x16_bf16 v[104:119], v[152:155], v[84:87], v[104:119]
  v_mfma_f32_32x32x16_bf16 v[120:135], v[156:159], v[84:87], v[120:135]
  s_bitcmp1_b32 s24, 1
  s_cselect_b32 s57, 64, 0
  s_add_u32 s57, s57, s3
  buffer_store_dwordx4 v[160:163], v14, s[16:19], s57 offen
  s_add_u32 s57, s57, 36864
  buffer_store_dwordx4 v[164:167], v14, s[16:19], s57 offen
  s_nop 9
  s_bitcmp1_b32 s24, 1
  s_cbranch_scc1 concat_heads__linear_kernel_hedgehog__softmax_full_mha__prompt_kernel_rw1b
  ds_write_b128 v13, v[104:107] offset:0
  ds_write_b128 v13, v[108:111] offset:1024
  ds_write_b128 v13, v[112:115] offset:2048
  ds_write_b128 v13, v[116:119] offset:3072
  s_branch concat_heads__linear_kernel_hedgehog__softmax_full_mha__prompt_kernel_rw2b
concat_heads__linear_kernel_hedgehog__softmax_full_mha__prompt_kernel_rw1b:
  ds_write_b128 v13, v[88:91] offset:0
  ds_write_b128 v13, v[92:95] offset:1024
  ds_write_b128 v13, v[96:99] offset:2048
  ds_write_b128 v13, v[100:103] offset:3072
  ds_write_b128 v7, v[120:123]
  v_mov_b32 v88, v104
  v_mov_b32 v89, v105
  v_mov_b32 v90, v106
  v_mov_b32 v91, v107
  v_mov_b32 v92, v108
  v_mov_b32 v93, v109
  v_mov_b32 v94, v110
  v_mov_b32 v95, v111
  v_mov_b32 v96, v112
  v_mov_b32 v97, v113
  v_mov_b32 v98, v114
  v_mov_b32 v99, v115
  v_mov_b32 v100, v116
  v_mov_b32 v101, v117
  v_mov_b32 v102, v118
  v_mov_b32 v103, v119
concat_heads__linear_kernel_hedgehog__softmax_full_mha__prompt_kernel_rw2b:
  s_waitcnt lgkmcnt(0)
  v_mov_b32 v2, 160768
  v_mov_b32 v3, 1
  s_mov_b64 exec, 1
  ds_add_u32 v2, v3
  s_mov_b64 exec, -1
  s_mov_b32 s61, 1048576
concat_heads__linear_kernel_hedgehog__softmax_full_mha__prompt_kernel_gb_37:
  ds_read_b32 v3, v2
  s_sub_u32 s61, s61, 1
  s_waitcnt lgkmcnt(0)
  s_cbranch_scc1 concat_heads__linear_kernel_hedgehog__softmax_full_mha__prompt_kernel_gb_37x
  v_cmp_gt_u32 vcc, 36, v3
  s_cbranch_vccz concat_heads__linear_kernel_hedgehog__softmax_full_mha__prompt_kernel_gb_37x
  s_branch concat_heads__linear_kernel_hedgehog__softmax_full_mha__prompt_kernel_gb_37
concat_heads__linear_kernel_hedgehog__softmax_full_mha__prompt_kernel_gb_37x:
  ds_read_b128 v[136:139], v12 offset:0
  ds_read_b128 v[140:143], v12 offset:1024
  ds_read_b128 v[144:147], v12 offset:2048
  ds_read_b128 v[148:151], v12 offset:3072
  ds_read_b128 v[152:155], v7
  s_add_u32 s56, s3, 1152
  s_bitcmp1_b32 s24, 1
  s_cselect_b32 s57, 64, 0
  s_add_u32 s57, s57, s56
  s_waitcnt lgkmcnt(0)
  v_add_f32 v88, v88, v136
  v_add_f32 v89, v89, v137
  v_add_f32 v90, v90, v138
  v_add_f32 v91, v91, v139
  v_add_f32 v92, v92, v140
  v_add_f32 v93, v93, v141
  v_add_f32 v94, v94, v142
  v_add_f32 v95, v95, v143
  v_add_f32 v96, v96, v144
  v_add_f32 v97, v97, v145
  v_add_f32 v98, v98, v146
  v_add_f32 v99, v99, v147
  v_add_f32 v100, v100, v148
  v_add_f32 v101, v101, v149
  v_add_f32 v102, v102, v150
  v_add_f32 v103, v103, v151
  v_cvt_pk_bf16_f32 v16, v88, v89
  v_cvt_pk_bf16_f32 v17, v90, v91
  v_cvt_pk_bf16_f32 v18, v92, v93
  v_cvt_pk_bf16_f32 v19, v94, v95
  v_cvt_pk_bf16_f32 v20, v96, v97
  v_cvt_pk_bf16_f32 v21, v98, v99
  v_cvt_pk_bf16_f32 v22, v100, v101
  v_cvt_pk_bf16_f32 v23, v102, v103
  s_nop 0
  v_permlane32_swap_b32 v16, v18
  v_permlane32_swap_b32 v17, v19
  v_permlane32_swap_b32 v20, v22
  v_permlane32_swap_b32 v21, v23
  s_nop 0
  v_permlane16_swap_b32 v16, v20
  v_permlane16_swap_b32 v17, v21
  v_permlane16_swap_b32 v18, v22
  v_permlane16_swap_b32 v19, v23
  buffer_store_dwordx4 v[16:19], v14, s[16:19], s57 offen
  s_add_u32 s57, s57, 36864
  buffer_store_dwordx4 v[20:23], v14, s[16:19], s57 offen
  s_bitcmp1_b32 s24, 1
  s_cbranch_scc1 concat_heads__linear_kernel_hedgehog__softmax_full_mha__prompt_kernel_rsb
  v_add_f32 v120, v120, v152
  v_add_f32 v121, v121, v153
  v_add_f32 v122, v122, v154
  v_add_f32 v123, v123, v155
  v_cvt_pk_bf16_f32 v24, v120, v121
  v_cvt_pk_bf16_f32 v25, v122, v123
  buffer_store_dwordx2 v[10:11], v15, s[16:19], s3 offen offset:128
  buffer_store_dwordx2 v[24:25], v15, s[16:19], s56 offen offset:128
concat_heads__linear_kernel_hedgehog__softmax_full_mha__prompt_kernel_rsb:
  s_endpgm
concat_heads__linear_kernel_hedgehog__softmax_full_mha__prompt_kernel_att:
  s_mov_b32 s28, 0x3ffff
  s_mov_b32 s29, 0x3ffff
  s_cmp_lt_u32 s24, 8
  s_cselect_b32 s58, 19456, 0
  s_add_u32 s58, s58, 0
  v_lshl_add_u32 v155, v0, 3, s58
  v_lshlrev_b32 v2, 4, v9
  v_add_u32 v2, s58, v2
  v_lshl_add_u32 v3, v8, 8, v2
  v_lshl_add_u32 v2, v8, 5, v2
  v_cmp_gt_u32 vcc, 16, v9
  v_add_u32 v3, 8256, v3
  v_add_u32 v2, 7936, v2
  v_cndmask_b32 v157, v2, v3, vcc
  v_add_u32 v3, 512, v3
  v_add_u32 v2, 1088, v2
  v_cndmask_b32 v22, v2, v3, vcc
  v_cmp_eq_u32 vcc, 18, v9
  v_mov_b32 v10, 0x3f803f80
  s_and_b32 s60, s32, 1
  s_lshl_b32 s60, s60, 2
  s_add_u32 s59, s58, s60
  s_add_u32 s59, s59, 17408
  v_lshl_add_u32 v156, v9, 3, s59
  v_cndmask_b32 v10, 0, v10, vcc
  v_mov_b32 v154, 0xdddd
  v_mov_b32 v153, 0
  v_mov_b32 v21, 0
  v_and_b32 v143, 3, v0
  v_lshlrev_b32 v143, 2, v143
  v_add_u32 v143, 161424, v143
  s_add_u32 s56, s97, 161472
  v_mov_b32 v23, s56
  s_and_b32 s56, s24, 3
  s_lshl_b32 s57, s56, 11
  s_add_u32 s57, s57, 38912
  v_lshl_add_u32 v4, v0, 3, s57
  s_lshl_b32 s57, s56, 9
  s_add_u32 s57, s57, s60
  s_add_u32 s57, s57, 47104
  v_lshl_add_u32 v5, v0, 3, s57
  v_mov_b32 v24, v10
  v_mov_b32 v25, v10
  v_mov_b32 v26, v10
  v_mov_b32 v27, v10
  v_mov_b32 v28, v10
  v_mov_b32 v29, v10
  v_mov_b32 v30, v10
  v_mov_b32 v31, v10
  v_mov_b32 v32, v10
  v_mov_b32 v33, v10
  v_mov_b32 v34, v10
  v_mov_b32 v35, v10
  v_mov_b32 v36, v10
  v_mov_b32 v37, v10
  v_mov_b32 v38, v10
  v_mov_b32 v39, v10
  v_mov_b32 v40, 0
  v_mov_b32 v41, 0
  v_mov_b32 v42, 0
  v_mov_b32 v43, 0
  v_mov_b32 v44, 0
  v_mov_b32 v45, 0
  v_mov_b32 v46, 0
  v_mov_b32 v47, 0
  v_mov_b32 v48, 0
  v_mov_b32 v49, 0
  v_mov_b32 v50, 0
  v_mov_b32 v51, 0
  v_mov_b32 v52, 0
  v_mov_b32 v53, 0
  v_mov_b32 v54, 0
  v_mov_b32 v55, 0
  v_mov_b32 v56, 0
  v_mov_b32 v57, 0
  v_mov_b32 v58, 0
  v_mov_b32 v59, 0
  v_mov_b32 v60, 0
  v_mov_b32 v61, 0
  v_mov_b32 v62, 0
  v_mov_b32 v63, 0
  v_mov_b32 v64, 0
  v_mov_b32 v65, 0
  v_mov_b32 v66, 0
  v_mov_b32 v67, 0
  v_mov_b32 v68, 0
  v_mov_b32 v69, 0
  v_mov_b32 v70, 0
  v_mov_b32 v71, 0
  v_and_b32 v2, 3, v0
  v_lshlrev_b32 v2, 2, v2
  v_add_u32 v2, 161408, v2
  s_mov_b32 s61, 1048576
concat_heads__linear_kernel_hedgehog__softmax_full_mha__prompt_kernel_gb_38:
  ds_read_b32 v3, v2
  s_sub_u32 s61, s61, 1
  s_waitcnt lgkmcnt(0)
  s_cbranch_scc1 concat_heads__linear_kernel_hedgehog__softmax_full_mha__prompt_kernel_gb_38x
  v_cmp_ne_u32 vcc, 0, v3
  s_cbranch_vccz concat_heads__linear_kernel_hedgehog__softmax_full_mha__prompt_kernel_gb_38x
  s_sleep 2
  s_branch concat_heads__linear_kernel_hedgehog__softmax_full_mha__prompt_kernel_gb_38
concat_heads__linear_kernel_hedgehog__softmax_full_mha__prompt_kernel_gb_38x:
  ds_read2st64_b64 v[144:147], v4 offset0:0 offset1:1
  ds_read2st64_b64 v[148:151], v4 offset0:2 offset1:3
  ds_read_b32 v152, v5
  ds_read2st64_b64 v[16:19], v155 offset0:0 offset1:1
  ds_read_b32 v20, v156 offset:0
  s_mov_b64 exec, s[28:29]
  ds_read_b128 v[24:27], v157 offset:0
  ds_read_b128 v[28:31], v22 offset:0
  s_mov_b64 exec, -1
  s_waitcnt lgkmcnt(0)
  v_mfma_f32_32x32x16_bf16 v[72:87], v[16:19], v[144:147], 0
  v_mfma_f32_32x32x16_bf16 v[88:103], v[16:19], v[148:151], 0
  s_mov_b64 exec, 1
  ds_write_b32 v23, v21 offset:0
  s_mov_b64 exec, -1
  ds_read2st64_b64 v[16:19], v155 offset0:2 offset1:3
  s_nop 5
  v_mfma_f32_32x32x4_2b_bf16 v[72:103], v[20:21], v[152:153], v[72:103]
  ds_read_b32 v20, v156 offset:256
  s_nop 15
  s_nop 0
  s_setprio 3
  s_waitcnt lgkmcnt(0)
  v_exp_f32 v72, v72
  v_exp_f32 v73, v73
  v_exp_f32 v74, v74
  v_exp_f32 v75, v75
  v_mfma_f32_32x32x4_2b_bf16 v[104:135], v[20:21], v[152:153], 0
  v_exp_f32 v76, v76
  v_exp_f32 v77, v77
  v_exp_f32 v78, v78
  v_exp_f32 v79, v79
  v_exp_f32 v80, v80
  v_exp_f32 v81, v81
  v_exp_f32 v82, v82
  v_exp_f32 v83, v83
  s_mov_b64 exec, s[28:29]
  ds_read_b128 v[32:35], v157 offset:1152
  ds_read_b128 v[36:39], v22 offset:1152
  s_mov_b64 exec, -1
  v_smfmac_f32_32x32x32_bf16 v[40:55], v[24:27], v[72:79], v154
  v_exp_f32 v84, v84
  v_exp_f32 v85, v85
  v_exp_f32 v86, v86
  v_exp_f32 v87, v87
  ds_read_b32 v20, v156 offset:512
  v_mfma_f32_32x32x16_bf16 v[104:119], v[16:19], v[144:147], v[104:119]
  v_exp_f32 v88, v88
  v_exp_f32 v89, v89
  v_exp_f32 v90, v90
  v_exp_f32 v91, v91
  v_mfma_f32_32x32x16_bf16 v[120:135], v[16:19], v[148:151], v[120:135]
  v_exp_f32 v92, v92
  v_exp_f32 v93, v93
  v_exp_f32 v94, v94
  v_exp_f32 v95, v95
  ds_read2st64_b64 v[16:19], v155 offset0:4 offset1:5
  v_smfmac_f32_32x32x32_bf16 v[40:55], v[28:31], v[80:87], v154
  v_exp_f32 v96, v96
  v_exp_f32 v97, v97
  v_exp_f32 v98, v98
  v_exp_f32 v99, v99
  v_smfmac_f32_32x32x32_bf16 v[56:71], v[24:27], v[88:95], v154
  v_exp_f32 v100, v100
  v_exp_f32 v101, v101
  v_exp_f32 v102, v102
  v_exp_f32 v103, v103
  s_setprio 2
  s_waitcnt lgkmcnt(0)
  v_exp_f32 v104, v104
  v_smfmac_f32_32x32x32_bf16 v[56:71], v[28:31], v[96:103], v154
  v_exp_f32 v105, v105
  v_exp_f32 v106, v106
  v_exp_f32 v107, v107
  v_mfma_f32_32x32x4_2b_bf16 v[72:103], v[20:21], v[152:153], 0
  v_exp_f32 v108, v108
  v_exp_f32 v109, v109
  v_exp_f32 v110, v110
  v_exp_f32 v111, v111
  v_exp_f32 v112, v112
  v_exp_f32 v113, v113
  v_exp_f32 v114, v114
  v_exp_f32 v115, v115
  s_mov_b64 exec, s[28:29]
  ds_read_b128 v[24:27], v157 offset:2304
  ds_read_b128 v[28:31], v22 offset:2304
  s_mov_b64 exec, -1
  v_smfmac_f32_32x32x32_bf16 v[40:55], v[32:35], v[104:111], v154
  v_exp_f32 v116, v116
  v_exp_f32 v117, v117
  v_exp_f32 v118, v118
  v_exp_f32 v119, v119
  ds_read_b32 v20, v156 offset:768
  v_mfma_f32_32x32x16_bf16 v[72:87], v[16:19], v[144:147], v[72:87]
  v_exp_f32 v120, v120
  v_exp_f32 v121, v121
  v_exp_f32 v122, v122
  v_exp_f32 v123, v123
  v_mfma_f32_32x32x16_bf16 v[88:103], v[16:19], v[148:151], v[88:103]
  v_exp_f32 v124, v124
  v_exp_f32 v125, v125
  v_exp_f32 v126, v126
  v_exp_f32 v127, v127
  ds_read2st64_b64 v[16:19], v155 offset0:6 offset1:7
  v_smfmac_f32_32x32x32_bf16 v[40:55], v[36:39], v[112:119], v154
  v_exp_f32 v128, v128
  v_exp_f32 v129, v129
  v_exp_f32 v130, v130
  v_exp_f32 v131, v131
  v_smfmac_f32_32x32x32_bf16 v[56:71], v[32:35], v[120:127], v154
  v_exp_f32 v132, v132
  v_exp_f32 v133, v133
  v_exp_f32 v134, v134
  v_exp_f32 v135, v135
  s_setprio 1
  s_waitcnt lgkmcnt(0)
  v_exp_f32 v72, v72
  v_smfmac_f32_32x32x32_bf16 v[56:71], v[36:39], v[128:135], v154
  v_exp_f32 v73, v73
  v_exp_f32 v74, v74
  v_exp_f32 v75, v75
  v_mfma_f32_32x32x4_2b_bf16 v[104:135], v[20:21], v[152:153], 0
  v_exp_f32 v76, v76
  v_exp_f32 v77, v77
  v_exp_f32 v78, v78
  v_exp_f32 v79, v79
  v_exp_f32 v80, v80
  v_exp_f32 v81, v81
  v_exp_f32 v82, v82
  v_exp_f32 v83, v83
  s_mov_b64 exec, s[28:29]
  ds_read_b128 v[32:35], v157 offset:3456
  ds_read_b128 v[36:39], v22 offset:3456
  s_mov_b64 exec, -1
  v_smfmac_f32_32x32x32_bf16 v[40:55], v[24:27], v[72:79], v154
  v_exp_f32 v84, v84
  v_exp_f32 v85, v85
  v_exp_f32 v86, v86
  v_exp_f32 v87, v87
  ds_read_b32 v20, v156 offset:1024
  v_mfma_f32_32x32x16_bf16 v[104:119], v[16:19], v[144:147], v[104:119]
  v_exp_f32 v88, v88
  v_exp_f32 v89, v89
  v_exp_f32 v90, v90
  v_exp_f32 v91, v91
  v_mfma_f32_32x32x16_bf16 v[120:135], v[16:19], v[148:151], v[120:135]
  v_exp_f32 v92, v92
  v_exp_f32 v93, v93
  v_exp_f32 v94, v94
  v_exp_f32 v95, v95
  ds_read2st64_b64 v[16:19], v155 offset0:8 offset1:9
  v_smfmac_f32_32x32x32_bf16 v[40:55], v[28:31], v[80:87], v154
  v_exp_f32 v96, v96
  v_exp_f32 v97, v97
  v_exp_f32 v98, v98
  v_exp_f32 v99, v99
  v_smfmac_f32_32x32x32_bf16 v[56:71], v[24:27], v[88:95], v154
  v_exp_f32 v100, v100
  v_exp_f32 v101, v101
  v_exp_f32 v102, v102
  v_exp_f32 v103, v103
  s_setprio 0
  s_waitcnt lgkmcnt(0)
  v_exp_f32 v104, v104
  v_smfmac_f32_32x32x32_bf16 v[56:71], v[28:31], v[96:103], v154
  v_exp_f32 v105, v105
  v_exp_f32 v106, v106
  v_exp_f32 v107, v107
  v_mfma_f32_32x32x4_2b_bf16 v[72:103], v[20:21], v[152:153], 0
  v_exp_f32 v108, v108
  v_exp_f32 v109, v109
  v_exp_f32 v110, v110
  v_exp_f32 v111, v111
  v_exp_f32 v112, v112
  v_exp_f32 v113, v113
  v_exp_f32 v114, v114
  v_exp_f32 v115, v115
  s_mov_b64 exec, s[28:29]
  ds_read_b128 v[24:27], v157 offset:4608
  ds_read_b128 v[28:31], v22 offset:4608
  s_mov_b64 exec, -1
  v_smfmac_f32_32x32x32_bf16 v[40:55], v[32:35], v[104:111], v154
  v_exp_f32 v116, v116
  v_exp_f32 v117, v117
  v_exp_f32 v118, v118
  v_exp_f32 v119, v119
  ds_read_b32 v20, v156 offset:1280
  v_mfma_f32_32x32x16_bf16 v[72:87], v[16:19], v[144:147], v[72:87]
  v_exp_f32 v120, v120
  v_exp_f32 v121, v121
  v_exp_f32 v122, v122
  v_exp_f32 v123, v123
  v_mfma_f32_32x32x16_bf16 v[88:103], v[16:19], v[148:151], v[88:103]
  v_exp_f32 v124, v124
  v_exp_f32 v125, v125
  v_exp_f32 v126, v126
  v_exp_f32 v127, v127
  ds_read2st64_b64 v[16:19], v155 offset0:10 offset1:11
  v_smfmac_f32_32x32x32_bf16 v[40:55], v[36:39], v[112:119], v154
  v_exp_f32 v128, v128
  v_exp_f32 v129, v129
  v_exp_f32 v130, v130
  v_exp_f32 v131, v131
  v_smfmac_f32_32x32x32_bf16 v[56:71], v[32:35], v[120:127], v154
  v_exp_f32 v132, v132
  v_exp_f32 v133, v133
  v_exp_f32 v134, v134
  v_exp_f32 v135, v135
  s_setprio 3
  s_waitcnt lgkmcnt(0)
  v_exp_f32 v72, v72
  v_smfmac_f32_32x32x32_bf16 v[56:71], v[36:39], v[128:135], v154
  v_exp_f32 v73, v73
  v_exp_f32 v74, v74
  v_exp_f32 v75, v75
  v_mfma_f32_32x32x4_2b_bf16 v[104:135], v[20:21], v[152:153], 0
  v_exp_f32 v76, v76
  v_exp_f32 v77, v77
  v_exp_f32 v78, v78
  v_exp_f32 v79, v79
  v_exp_f32 v80, v80
  v_exp_f32 v81, v81
  v_exp_f32 v82, v82
  v_exp_f32 v83, v83
  s_mov_b64 exec, s[28:29]
  ds_read_b128 v[32:35], v157 offset:5760
  ds_read_b128 v[36:39], v22 offset:5760
  s_mov_b64 exec, -1
  v_smfmac_f32_32x32x32_bf16 v[40:55], v[24:27], v[72:79], v154
  v_exp_f32 v84, v84
  v_exp_f32 v85, v85
  v_exp_f32 v86, v86
  v_exp_f32 v87, v87
  ds_read_b32 v20, v156 offset:1536
  v_mfma_f32_32x32x16_bf16 v[104:119], v[16:19], v[144:147], v[104:119]
  v_exp_f32 v88, v88
  v_exp_f32 v89, v89
  v_exp_f32 v90, v90
  v_exp_f32 v91, v91
  v_mfma_f32_32x32x16_bf16 v[120:135], v[16:19], v[148:151], v[120:135]
  v_exp_f32 v92, v92
  v_exp_f32 v93, v93
  v_exp_f32 v94, v94
  v_exp_f32 v95, v95
  ds_read2st64_b64 v[16:19], v155 offset0:12 offset1:13
  v_smfmac_f32_32x32x32_bf16 v[40:55], v[28:31], v[80:87], v154
  v_exp_f32 v96, v96
  v_exp_f32 v97, v97
  v_exp_f32 v98, v98
  v_exp_f32 v99, v99
  v_smfmac_f32_32x32x32_bf16 v[56:71], v[24:27], v[88:95], v154
  v_exp_f32 v100, v100
  v_exp_f32 v101, v101
  v_exp_f32 v102, v102
  v_exp_f32 v103, v103
  s_setprio 2
  s_waitcnt lgkmcnt(0)
  v_exp_f32 v104, v104
  v_smfmac_f32_32x32x32_bf16 v[56:71], v[28:31], v[96:103], v154
  v_exp_f32 v105, v105
  v_exp_f32 v106, v106
  v_exp_f32 v107, v107
  v_mfma_f32_32x32x4_2b_bf16 v[72:103], v[20:21], v[152:153], 0
  v_exp_f32 v108, v108
  v_exp_f32 v109, v109
  v_exp_f32 v110, v110
  v_exp_f32 v111, v111
  v_exp_f32 v112, v112
  v_exp_f32 v113, v113
  v_exp_f32 v114, v114
  v_exp_f32 v115, v115
  s_mov_b64 exec, s[28:29]
  ds_read_b128 v[24:27], v157 offset:6912
  ds_read_b128 v[28:31], v22 offset:6912
  s_mov_b64 exec, -1
  v_smfmac_f32_32x32x32_bf16 v[40:55], v[32:35], v[104:111], v154
  v_exp_f32 v116, v116
  v_exp_f32 v117, v117
  v_exp_f32 v118, v118
  v_exp_f32 v119, v119
  ds_read_b32 v20, v156 offset:1792
  v_mfma_f32_32x32x16_bf16 v[72:87], v[16:19], v[144:147], v[72:87]
  v_exp_f32 v120, v120
  v_exp_f32 v121, v121
  v_exp_f32 v122, v122
  v_exp_f32 v123, v123
  v_mfma_f32_32x32x16_bf16 v[88:103], v[16:19], v[148:151], v[88:103]
  v_exp_f32 v124, v124
  v_exp_f32 v125, v125
  v_exp_f32 v126, v126
  v_exp_f32 v127, v127
  ds_read2st64_b64 v[16:19], v155 offset0:14 offset1:15
  v_smfmac_f32_32x32x32_bf16 v[40:55], v[36:39], v[112:119], v154
  v_exp_f32 v128, v128
  v_exp_f32 v129, v129
  v_exp_f32 v130, v130
  v_exp_f32 v131, v131
  v_smfmac_f32_32x32x32_bf16 v[56:71], v[32:35], v[120:127], v154
  v_exp_f32 v132, v132
  v_exp_f32 v133, v133
  v_exp_f32 v134, v134
  v_exp_f32 v135, v135
  s_setprio 1
  s_waitcnt lgkmcnt(0)
  v_exp_f32 v72, v72
  v_smfmac_f32_32x32x32_bf16 v[56:71], v[36:39], v[128:135], v154
  v_exp_f32 v73, v73
  v_exp_f32 v74, v74
  v_exp_f32 v75, v75
  v_mfma_f32_32x32x4_2b_bf16 v[104:135], v[20:21], v[152:153], 0
  v_exp_f32 v76, v76
  v_exp_f32 v77, v77
  v_exp_f32 v78, v78
  v_exp_f32 v79, v79
  v_exp_f32 v80, v80
  v_exp_f32 v81, v81
  v_exp_f32 v82, v82
  v_exp_f32 v83, v83
  ds_read_b32 v142, v143 offset:0
  s_mov_b64 exec, s[28:29]
  ds_read_b128 v[32:35], v157 offset:8064
  ds_read_b128 v[36:39], v22 offset:8064
  s_mov_b64 exec, -1
  v_smfmac_f32_32x32x32_bf16 v[40:55], v[24:27], v[72:79], v154
  v_exp_f32 v84, v84
  v_exp_f32 v85, v85
  v_exp_f32 v86, v86
  v_exp_f32 v87, v87
  s_nop 0
  v_mfma_f32_32x32x16_bf16 v[104:119], v[16:19], v[144:147], v[104:119]
  v_exp_f32 v88, v88
  v_exp_f32 v89, v89
  v_exp_f32 v90, v90
  v_exp_f32 v91, v91
  v_mfma_f32_32x32x16_bf16 v[120:135], v[16:19], v[148:151], v[120:135]
  v_exp_f32 v92, v92
  v_exp_f32 v93, v93
  v_exp_f32 v94, v94
  v_exp_f32 v95, v95
  s_waitcnt lgkmcnt(0)
  v_cmp_ne_u32 vcc, 0, v142
  s_mov_b64 exec, 1
  ds_write_b32 v23, v21 offset:32
  s_mov_b64 exec, -1
  s_cbranch_vccnz concat_heads__linear_kernel_hedgehog__softmax_full_mha__prompt_kernel_qs1
concat_heads__linear_kernel_hedgehog__softmax_full_mha__prompt_kernel_qr1:
  ds_read2st64_b64 v[16:19], v155 offset0:76 offset1:77
  ds_read_b32 v20, v156 offset:38912
  v_smfmac_f32_32x32x32_bf16 v[40:55], v[28:31], v[80:87], v154
  v_exp_f32 v96, v96
  v_exp_f32 v97, v97
  v_exp_f32 v98, v98
  v_exp_f32 v99, v99
  v_smfmac_f32_32x32x32_bf16 v[56:71], v[24:27], v[88:95], v154
  v_exp_f32 v100, v100
  v_exp_f32 v101, v101
  v_exp_f32 v102, v102
  v_exp_f32 v103, v103
  s_setprio 0
  s_waitcnt lgkmcnt(0)
  v_exp_f32 v104, v104
  v_smfmac_f32_32x32x32_bf16 v[56:71], v[28:31], v[96:103], v154
  v_exp_f32 v105, v105
  v_exp_f32 v106, v106
  v_exp_f32 v107, v107
  v_mfma_f32_32x32x4_2b_bf16 v[72:103], v[20:21], v[152:153], 0
  v_exp_f32 v108, v108
  v_exp_f32 v109, v109
  v_exp_f32 v110, v110
  v_exp_f32 v111, v111
  v_exp_f32 v112, v112
  v_exp_f32 v113, v113
  v_exp_f32 v114, v114
  v_exp_f32 v115, v115
  s_mov_b64 exec, s[28:29]
  ds_read_b128 v[24:27], v157 offset:38912
  ds_read_b128 v[28:31], v22 offset:38912
  s_mov_b64 exec, -1
  v_smfmac_f32_32x32x32_bf16 v[40:55], v[32:35], v[104:111], v154
  v_exp_f32 v116, v116
  v_exp_f32 v117, v117
  v_exp_f32 v118, v118
  v_exp_f32 v119, v119
  ds_read_b32 v20, v156 offset:39168
  v_mfma_f32_32x32x16_bf16 v[72:87], v[16:19], v[144:147], v[72:87]
  v_exp_f32 v120, v120
  v_exp_f32 v121, v121
  v_exp_f32 v122, v122
  v_exp_f32 v123, v123
  v_mfma_f32_32x32x16_bf16 v[88:103], v[16:19], v[148:151], v[88:103]
  v_exp_f32 v124, v124
  v_exp_f32 v125, v125
  v_exp_f32 v126, v126
  v_exp_f32 v127, v127
  ds_read2st64_b64 v[16:19], v155 offset0:78 offset1:79
  v_smfmac_f32_32x32x32_bf16 v[40:55], v[36:39], v[112:119], v154
  v_exp_f32 v128, v128
  v_exp_f32 v129, v129
  v_exp_f32 v130, v130
  v_exp_f32 v131, v131
  v_smfmac_f32_32x32x32_bf16 v[56:71], v[32:35], v[120:127], v154
  v_exp_f32 v132, v132
  v_exp_f32 v133, v133
  v_exp_f32 v134, v134
  v_exp_f32 v135, v135
  s_setprio 3
  s_waitcnt lgkmcnt(0)
  v_exp_f32 v72, v72
  v_smfmac_f32_32x32x32_bf16 v[56:71], v[36:39], v[128:135], v154
  v_exp_f32 v73, v73
  v_exp_f32 v74, v74
  v_exp_f32 v75, v75
  v_mfma_f32_32x32x4_2b_bf16 v[104:135], v[20:21], v[152:153], 0
  v_exp_f32 v76, v76
  v_exp_f32 v77, v77
  v_exp_f32 v78, v78
  v_exp_f32 v79, v79
  v_exp_f32 v80, v80
  v_exp_f32 v81, v81
  v_exp_f32 v82, v82
  v_exp_f32 v83, v83
  s_mov_b64 exec, s[28:29]
  ds_read_b128 v[32:35], v157 offset:40064
  ds_read_b128 v[36:39], v22 offset:40064
  s_mov_b64 exec, -1
  v_smfmac_f32_32x32x32_bf16 v[40:55], v[24:27], v[72:79], v154
  v_exp_f32 v84, v84
  v_exp_f32 v85, v85
  v_exp_f32 v86, v86
  v_exp_f32 v87, v87
  ds_read_b32 v20, v156 offset:39424
  v_mfma_f32_32x32x16_bf16 v[104:119], v[16:19], v[144:147], v[104:119]
  v_exp_f32 v88, v88
  v_exp_f32 v89, v89
  v_exp_f32 v90, v90
  v_exp_f32 v91, v91
  v_mfma_f32_32x32x16_bf16 v[120:135], v[16:19], v[148:151], v[120:135]
  v_exp_f32 v92, v92
  v_exp_f32 v93, v93
  v_exp_f32 v94, v94
  v_exp_f32 v95, v95
  ds_read2st64_b64 v[16:19], v155 offset0:80 offset1:81
  v_smfmac_f32_32x32x32_bf16 v[40:55], v[28:31], v[80:87], v154
  v_exp_f32 v96, v96
  v_exp_f32 v97, v97
  v_exp_f32 v98, v98
  v_exp_f32 v99, v99
  v_smfmac_f32_32x32x32_bf16 v[56:71], v[24:27], v[88:95], v154
  v_exp_f32 v100, v100
  v_exp_f32 v101, v101
  v_exp_f32 v102, v102
  v_exp_f32 v103, v103
  s_setprio 2
  s_waitcnt lgkmcnt(0)
  v_exp_f32 v104, v104
  v_smfmac_f32_32x32x32_bf16 v[56:71], v[28:31], v[96:103], v154
  v_exp_f32 v105, v105
  v_exp_f32 v106, v106
  v_exp_f32 v107, v107
  v_mfma_f32_32x32x4_2b_bf16 v[72:103], v[20:21], v[152:153], 0
  v_exp_f32 v108, v108
  v_exp_f32 v109, v109
  v_exp_f32 v110, v110
  v_exp_f32 v111, v111
  v_exp_f32 v112, v112
  v_exp_f32 v113, v113
  v_exp_f32 v114, v114
  v_exp_f32 v115, v115
  s_mov_b64 exec, s[28:29]
  ds_read_b128 v[24:27], v157 offset:41216
  ds_read_b128 v[28:31], v22 offset:41216
  s_mov_b64 exec, -1
  v_smfmac_f32_32x32x32_bf16 v[40:55], v[32:35], v[104:111], v154
  v_exp_f32 v116, v116
  v_exp_f32 v117, v117
  v_exp_f32 v118, v118
  v_exp_f32 v119, v119
  ds_read_b32 v20, v156 offset:39680
  v_mfma_f32_32x32x16_bf16 v[72:87], v[16:19], v[144:147], v[72:87]
  v_exp_f32 v120, v120
  v_exp_f32 v121, v121
  v_exp_f32 v122, v122
  v_exp_f32 v123, v123
  v_mfma_f32_32x32x16_bf16 v[88:103], v[16:19], v[148:151], v[88:103]
  v_exp_f32 v124, v124
  v_exp_f32 v125, v125
  v_exp_f32 v126, v126
  v_exp_f32 v127, v127
  ds_read2st64_b64 v[16:19], v155 offset0:82 offset1:83
  v_smfmac_f32_32x32x32_bf16 v[40:55], v[36:39], v[112:119], v154
  v_exp_f32 v128, v128
  v_exp_f32 v129, v129
  v_exp_f32 v130, v130
  v_exp_f32 v131, v131
  v_smfmac_f32_32x32x32_bf16 v[56:71], v[32:35], v[120:127], v154
  v_exp_f32 v132, v132
  v_exp_f32 v133, v133
  v_exp_f32 v134, v134
  v_exp_f32 v135, v135
  s_setprio 1
  s_waitcnt lgkmcnt(0)
  v_exp_f32 v72, v72
  v_smfmac_f32_32x32x32_bf16 v[56:71], v[36:39], v[128:135], v154
  v_exp_f32 v73, v73
  v_exp_f32 v74, v74
  v_exp_f32 v75, v75
  v_mfma_f32_32x32x4_2b_bf16 v[104:135], v[20:21], v[152:153], 0
  v_exp_f32 v76, v76
  v_exp_f32 v77, v77
  v_exp_f32 v78, v78
  v_exp_f32 v79, v79
  v_exp_f32 v80, v80
  v_exp_f32 v81, v81
  v_exp_f32 v82, v82
  v_exp_f32 v83, v83
  s_mov_b64 exec, s[28:29]
  ds_read_b128 v[32:35], v157 offset:42368
  ds_read_b128 v[36:39], v22 offset:42368
  s_mov_b64 exec, -1
  v_smfmac_f32_32x32x32_bf16 v[40:55], v[24:27], v[72:79], v154
  v_exp_f32 v84, v84
  v_exp_f32 v85, v85
  v_exp_f32 v86, v86
  v_exp_f32 v87, v87
  ds_read_b32 v20, v156 offset:39936
  v_mfma_f32_32x32x16_bf16 v[104:119], v[16:19], v[144:147], v[104:119]
  v_exp_f32 v88, v88
  v_exp_f32 v89, v89
  v_exp_f32 v90, v90
  v_exp_f32 v91, v91
  v_mfma_f32_32x32x16_bf16 v[120:135], v[16:19], v[148:151], v[120:135]
  v_exp_f32 v92, v92
  v_exp_f32 v93, v93
  v_exp_f32 v94, v94
  v_exp_f32 v95, v95
  ds_read2st64_b64 v[16:19], v155 offset0:84 offset1:85
  v_smfmac_f32_32x32x32_bf16 v[40:55], v[28:31], v[80:87], v154
  v_exp_f32 v96, v96
  v_exp_f32 v97, v97
  v_exp_f32 v98, v98
  v_exp_f32 v99, v99
  v_smfmac_f32_32x32x32_bf16 v[56:71], v[24:27], v[88:95], v154
  v_exp_f32 v100, v100
  v_exp_f32 v101, v101
  v_exp_f32 v102, v102
  v_exp_f32 v103, v103
  s_setprio 0
  s_waitcnt lgkmcnt(0)
  v_exp_f32 v104, v104
  v_smfmac_f32_32x32x32_bf16 v[56:71], v[28:31], v[96:103], v154
  v_exp_f32 v105, v105
  v_exp_f32 v106, v106
  v_exp_f32 v107, v107
  v_mfma_f32_32x32x4_2b_bf16 v[72:103], v[20:21], v[152:153], 0
  v_exp_f32 v108, v108
  v_exp_f32 v109, v109
  v_exp_f32 v110, v110
  v_exp_f32 v111, v111
  v_exp_f32 v112, v112
  v_exp_f32 v113, v113
  v_exp_f32 v114, v114
  v_exp_f32 v115, v115
  s_mov_b64 exec, s[28:29]
  ds_read_b128 v[24:27], v157 offset:43520
  ds_read_b128 v[28:31], v22 offset:43520
  s_mov_b64 exec, -1
  v_smfmac_f32_32x32x32_bf16 v[40:55], v[32:35], v[104:111], v154
  v_exp_f32 v116, v116
  v_exp_f32 v117, v117
  v_exp_f32 v118, v118
  v_exp_f32 v119, v119
  ds_read_b32 v20, v156 offset:40192
  v_mfma_f32_32x32x16_bf16 v[72:87], v[16:19], v[144:147], v[72:87]
  v_exp_f32 v120, v120
  v_exp_f32 v121, v121
  v_exp_f32 v122, v122
  v_exp_f32 v123, v123
  v_mfma_f32_32x32x16_bf16 v[88:103], v[16:19], v[148:151], v[88:103]
  v_exp_f32 v124, v124
  v_exp_f32 v125, v125
  v_exp_f32 v126, v126
  v_exp_f32 v127, v127
  ds_read2st64_b64 v[16:19], v155 offset0:86 offset1:87
  v_smfmac_f32_32x32x32_bf16 v[40:55], v[36:39], v[112:119], v154
  v_exp_f32 v128, v128
  v_exp_f32 v129, v129
  v_exp_f32 v130, v130
  v_exp_f32 v131, v131
  v_smfmac_f32_32x32x32_bf16 v[56:71], v[32:35], v[120:127], v154
  v_exp_f32 v132, v132
  v_exp_f32 v133, v133
  v_exp_f32 v134, v134
  v_exp_f32 v135, v135
  s_setprio 3
  s_waitcnt lgkmcnt(0)
  v_exp_f32 v72, v72
  v_smfmac_f32_32x32x32_bf16 v[56:71], v[36:39], v[128:135], v154
  v_exp_f32 v73, v73
  v_exp_f32 v74, v74
  v_exp_f32 v75, v75
  v_mfma_f32_32x32x4_2b_bf16 v[104:135], v[20:21], v[152:153], 0
  v_exp_f32 v76, v76
  v_exp_f32 v77, v77
  v_exp_f32 v78, v78
  v_exp_f32 v79, v79
  v_exp_f32 v80, v80
  v_exp_f32 v81, v81
  v_exp_f32 v82, v82
  v_exp_f32 v83, v83
  s_mov_b64 exec, s[28:29]
  ds_read_b128 v[32:35], v157 offset:44672
  ds_read_b128 v[36:39], v22 offset:44672
  s_mov_b64 exec, -1
  v_smfmac_f32_32x32x32_bf16 v[40:55], v[24:27], v[72:79], v154
  v_exp_f32 v84, v84
  v_exp_f32 v85, v85
  v_exp_f32 v86, v86
  v_exp_f32 v87, v87
  ds_read_b32 v20, v156 offset:40448
  v_mfma_f32_32x32x16_bf16 v[104:119], v[16:19], v[144:147], v[104:119]
  v_exp_f32 v88, v88
  v_exp_f32 v89, v89
  v_exp_f32 v90, v90
  v_exp_f32 v91, v91
  v_mfma_f32_32x32x16_bf16 v[120:135], v[16:19], v[148:151], v[120:135]
  v_exp_f32 v92, v92
  v_exp_f32 v93, v93
  v_exp_f32 v94, v94
  v_exp_f32 v95, v95
  ds_read2st64_b64 v[16:19], v155 offset0:88 offset1:89
  v_smfmac_f32_32x32x32_bf16 v[40:55], v[28:31], v[80:87], v154
  v_exp_f32 v96, v96
  v_exp_f32 v97, v97
  v_exp_f32 v98, v98
  v_exp_f32 v99, v99
  v_smfmac_f32_32x32x32_bf16 v[56:71], v[24:27], v[88:95], v154
  v_exp_f32 v100, v100
  v_exp_f32 v101, v101
  v_exp_f32 v102, v102
  v_exp_f32 v103, v103
  s_setprio 2
  s_waitcnt lgkmcnt(0)
  v_exp_f32 v104, v104
  v_smfmac_f32_32x32x32_bf16 v[56:71], v[28:31], v[96:103], v154
  v_exp_f32 v105, v105
  v_exp_f32 v106, v106
  v_exp_f32 v107, v107
  v_mfma_f32_32x32x4_2b_bf16 v[72:103], v[20:21], v[152:153], 0
  v_exp_f32 v108, v108
  v_exp_f32 v109, v109
  v_exp_f32 v110, v110
  v_exp_f32 v111, v111
  v_exp_f32 v112, v112
  v_exp_f32 v113, v113
  v_exp_f32 v114, v114
  v_exp_f32 v115, v115
  s_mov_b64 exec, s[28:29]
  ds_read_b128 v[24:27], v157 offset:45824
  ds_read_b128 v[28:31], v22 offset:45824
  s_mov_b64 exec, -1
  v_smfmac_f32_32x32x32_bf16 v[40:55], v[32:35], v[104:111], v154
  v_exp_f32 v116, v116
  v_exp_f32 v117, v117
  v_exp_f32 v118, v118
  v_exp_f32 v119, v119
  ds_read_b32 v20, v156 offset:40704
  v_mfma_f32_32x32x16_bf16 v[72:87], v[16:19], v[144:147], v[72:87]
  v_exp_f32 v120, v120
  v_exp_f32 v121, v121
  v_exp_f32 v122, v122
  v_exp_f32 v123, v123
  v_mfma_f32_32x32x16_bf16 v[88:103], v[16:19], v[148:151], v[88:103]
  v_exp_f32 v124, v124
  v_exp_f32 v125, v125
  v_exp_f32 v126, v126
  v_exp_f32 v127, v127
  ds_read2st64_b64 v[16:19], v155 offset0:90 offset1:91
  v_smfmac_f32_32x32x32_bf16 v[40:55], v[36:39], v[112:119], v154
  v_exp_f32 v128, v128
  v_exp_f32 v129, v129
  v_exp_f32 v130, v130
  v_exp_f32 v131, v131
  v_smfmac_f32_32x32x32_bf16 v[56:71], v[32:35], v[120:127], v154
  v_exp_f32 v132, v132
  v_exp_f32 v133, v133
  v_exp_f32 v134, v134
  v_exp_f32 v135, v135
  s_setprio 1
  s_waitcnt lgkmcnt(0)
  v_exp_f32 v72, v72
  v_smfmac_f32_32x32x32_bf16 v[56:71], v[36:39], v[128:135], v154
  v_exp_f32 v73, v73
  v_exp_f32 v74, v74
  v_exp_f32 v75, v75
  v_mfma_f32_32x32x4_2b_bf16 v[104:135], v[20:21], v[152:153], 0
  v_exp_f32 v76, v76
  v_exp_f32 v77, v77
  v_exp_f32 v78, v78
  v_exp_f32 v79, v79
  v_exp_f32 v80, v80
  v_exp_f32 v81, v81
  v_exp_f32 v82, v82
  v_exp_f32 v83, v83
  ds_read_b32 v142, v143 offset:16
  s_mov_b64 exec, s[28:29]
  ds_read_b128 v[32:35], v157 offset:46976
  ds_read_b128 v[36:39], v22 offset:46976
  s_mov_b64 exec, -1
  v_smfmac_f32_32x32x32_bf16 v[40:55], v[24:27], v[72:79], v154
  v_exp_f32 v84, v84
  v_exp_f32 v85, v85
  v_exp_f32 v86, v86
  v_exp_f32 v87, v87
  s_nop 0
  v_mfma_f32_32x32x16_bf16 v[104:119], v[16:19], v[144:147], v[104:119]
  v_exp_f32 v88, v88
  v_exp_f32 v89, v89
  v_exp_f32 v90, v90
  v_exp_f32 v91, v91
  v_mfma_f32_32x32x16_bf16 v[120:135], v[16:19], v[148:151], v[120:135]
  v_exp_f32 v92, v92
  v_exp_f32 v93, v93
  v_exp_f32 v94, v94
  v_exp_f32 v95, v95
  s_waitcnt lgkmcnt(0)
  v_cmp_ne_u32 vcc, 0, v142
  s_mov_b64 exec, 1
  ds_write_b32 v23, v21 offset:64
  s_mov_b64 exec, -1
  s_cbranch_vccnz concat_heads__linear_kernel_hedgehog__softmax_full_mha__prompt_kernel_qs2
concat_heads__linear_kernel_hedgehog__softmax_full_mha__prompt_kernel_qr2:
  ds_read2st64_b64 v[16:19], v155 offset0:0 offset1:1
  ds_read_b32 v20, v156 offset:0
  v_smfmac_f32_32x32x32_bf16 v[40:55], v[28:31], v[80:87], v154
  v_exp_f32 v96, v96
  v_exp_f32 v97, v97
  v_exp_f32 v98, v98
  v_exp_f32 v99, v99
  v_smfmac_f32_32x32x32_bf16 v[56:71], v[24:27], v[88:95], v154
  v_exp_f32 v100, v100
  v_exp_f32 v101, v101
  v_exp_f32 v102, v102
  v_exp_f32 v103, v103
  s_setprio 0
  s_waitcnt lgkmcnt(0)
  v_exp_f32 v104, v104
  v_smfmac_f32_32x32x32_bf16 v[56:71], v[28:31], v[96:103], v154
  v_exp_f32 v105, v105
  v_exp_f32 v106, v106
  v_exp_f32 v107, v107
  v_mfma_f32_32x32x4_2b_bf16 v[72:103], v[20:21], v[152:153], 0
  v_exp_f32 v108, v108
  v_exp_f32 v109, v109
  v_exp_f32 v110, v110
  v_exp_f32 v111, v111
  v_exp_f32 v112, v112
  v_exp_f32 v113, v113
  v_exp_f32 v114, v114
  v_exp_f32 v115, v115
  s_mov_b64 exec, s[28:29]
  ds_read_b128 v[24:27], v157 offset:0
  ds_read_b128 v[28:31], v22 offset:0
  s_mov_b64 exec, -1
  v_smfmac_f32_32x32x32_bf16 v[40:55], v[32:35], v[104:111], v154
  v_exp_f32 v116, v116
  v_exp_f32 v117, v117
  v_exp_f32 v118, v118
  v_exp_f32 v119, v119
  ds_read_b32 v20, v156 offset:256
  v_mfma_f32_32x32x16_bf16 v[72:87], v[16:19], v[144:147], v[72:87]
  v_exp_f32 v120, v120
  v_exp_f32 v121, v121
  v_exp_f32 v122, v122
  v_exp_f32 v123, v123
  v_mfma_f32_32x32x16_bf16 v[88:103], v[16:19], v[148:151], v[88:103]
  v_exp_f32 v124, v124
  v_exp_f32 v125, v125
  v_exp_f32 v126, v126
  v_exp_f32 v127, v127
  ds_read2st64_b64 v[16:19], v155 offset0:2 offset1:3
  v_smfmac_f32_32x32x32_bf16 v[40:55], v[36:39], v[112:119], v154
  v_exp_f32 v128, v128
  v_exp_f32 v129, v129
  v_exp_f32 v130, v130
  v_exp_f32 v131, v131
  v_smfmac_f32_32x32x32_bf16 v[56:71], v[32:35], v[120:127], v154
  v_exp_f32 v132, v132
  v_exp_f32 v133, v133
  v_exp_f32 v134, v134
  v_exp_f32 v135, v135
  s_setprio 3
  s_waitcnt lgkmcnt(0)
  v_exp_f32 v72, v72
  v_smfmac_f32_32x32x32_bf16 v[56:71], v[36:39], v[128:135], v154
  v_exp_f32 v73, v73
  v_exp_f32 v74, v74
  v_exp_f32 v75, v75
  v_mfma_f32_32x32x4_2b_bf16 v[104:135], v[20:21], v[152:153], 0
  v_exp_f32 v76, v76
  v_exp_f32 v77, v77
  v_exp_f32 v78, v78
  v_exp_f32 v79, v79
  v_exp_f32 v80, v80
  v_exp_f32 v81, v81
  v_exp_f32 v82, v82
  v_exp_f32 v83, v83
  s_mov_b64 exec, s[28:29]
  ds_read_b128 v[32:35], v157 offset:1152
  ds_read_b128 v[36:39], v22 offset:1152
  s_mov_b64 exec, -1
  v_smfmac_f32_32x32x32_bf16 v[40:55], v[24:27], v[72:79], v154
  v_exp_f32 v84, v84
  v_exp_f32 v85, v85
  v_exp_f32 v86, v86
  v_exp_f32 v87, v87
  ds_read_b32 v20, v156 offset:512
  v_mfma_f32_32x32x16_bf16 v[104:119], v[16:19], v[144:147], v[104:119]
  v_exp_f32 v88, v88
  v_exp_f32 v89, v89
  v_exp_f32 v90, v90
  v_exp_f32 v91, v91
  v_mfma_f32_32x32x16_bf16 v[120:135], v[16:19], v[148:151], v[120:135]
  v_exp_f32 v92, v92
  v_exp_f32 v93, v93
  v_exp_f32 v94, v94
  v_exp_f32 v95, v95
  ds_read2st64_b64 v[16:19], v155 offset0:4 offset1:5
  v_smfmac_f32_32x32x32_bf16 v[40:55], v[28:31], v[80:87], v154
  v_exp_f32 v96, v96
  v_exp_f32 v97, v97
  v_exp_f32 v98, v98
  v_exp_f32 v99, v99
  v_smfmac_f32_32x32x32_bf16 v[56:71], v[24:27], v[88:95], v154
  v_exp_f32 v100, v100
  v_exp_f32 v101, v101
  v_exp_f32 v102, v102
  v_exp_f32 v103, v103
  s_setprio 2
  s_waitcnt lgkmcnt(0)
  v_exp_f32 v104, v104
  v_smfmac_f32_32x32x32_bf16 v[56:71], v[28:31], v[96:103], v154
  v_exp_f32 v105, v105
  v_exp_f32 v106, v106
  v_exp_f32 v107, v107
  v_mfma_f32_32x32x4_2b_bf16 v[72:103], v[20:21], v[152:153], 0
  v_exp_f32 v108, v108
  v_exp_f32 v109, v109
  v_exp_f32 v110, v110
  v_exp_f32 v111, v111
  v_exp_f32 v112, v112
  v_exp_f32 v113, v113
  v_exp_f32 v114, v114
  v_exp_f32 v115, v115
  s_mov_b64 exec, s[28:29]
  ds_read_b128 v[24:27], v157 offset:2304
  ds_read_b128 v[28:31], v22 offset:2304
  s_mov_b64 exec, -1
  v_smfmac_f32_32x32x32_bf16 v[40:55], v[32:35], v[104:111], v154
  v_exp_f32 v116, v116
  v_exp_f32 v117, v117
  v_exp_f32 v118, v118
  v_exp_f32 v119, v119
  ds_read_b32 v20, v156 offset:768
  v_mfma_f32_32x32x16_bf16 v[72:87], v[16:19], v[144:147], v[72:87]
  v_exp_f32 v120, v120
  v_exp_f32 v121, v121
  v_exp_f32 v122, v122
  v_exp_f32 v123, v123
  v_mfma_f32_32x32x16_bf16 v[88:103], v[16:19], v[148:151], v[88:103]
  v_exp_f32 v124, v124
  v_exp_f32 v125, v125
  v_exp_f32 v126, v126
  v_exp_f32 v127, v127
  ds_read2st64_b64 v[16:19], v155 offset0:6 offset1:7
  v_smfmac_f32_32x32x32_bf16 v[40:55], v[36:39], v[112:119], v154
  v_exp_f32 v128, v128
  v_exp_f32 v129, v129
  v_exp_f32 v130, v130
  v_exp_f32 v131, v131
  v_smfmac_f32_32x32x32_bf16 v[56:71], v[32:35], v[120:127], v154
  v_exp_f32 v132, v132
  v_exp_f32 v133, v133
  v_exp_f32 v134, v134
  v_exp_f32 v135, v135
  s_setprio 1
  s_waitcnt lgkmcnt(0)
  v_exp_f32 v72, v72
  v_smfmac_f32_32x32x32_bf16 v[56:71], v[36:39], v[128:135], v154
  v_exp_f32 v73, v73
  v_exp_f32 v74, v74
  v_exp_f32 v75, v75
  v_mfma_f32_32x32x4_2b_bf16 v[104:135], v[20:21], v[152:153], 0
  v_exp_f32 v76, v76
  v_exp_f32 v77, v77
  v_exp_f32 v78, v78
  v_exp_f32 v79, v79
  v_exp_f32 v80, v80
  v_exp_f32 v81, v81
  v_exp_f32 v82, v82
  v_exp_f32 v83, v83
  s_mov_b64 exec, s[28:29]
  ds_read_b128 v[32:35], v157 offset:3456
  ds_read_b128 v[36:39], v22 offset:3456
  s_mov_b64 exec, -1
  v_smfmac_f32_32x32x32_bf16 v[40:55], v[24:27], v[72:79], v154
  v_exp_f32 v84, v84
  v_exp_f32 v85, v85
  v_exp_f32 v86, v86
  v_exp_f32 v87, v87
  ds_read_b32 v20, v156 offset:1024
  v_mfma_f32_32x32x16_bf16 v[104:119], v[16:19], v[144:147], v[104:119]
  v_exp_f32 v88, v88
  v_exp_f32 v89, v89
  v_exp_f32 v90, v90
  v_exp_f32 v91, v91
  v_mfma_f32_32x32x16_bf16 v[120:135], v[16:19], v[148:151], v[120:135]
  v_exp_f32 v92, v92
  v_exp_f32 v93, v93
  v_exp_f32 v94, v94
  v_exp_f32 v95, v95
  ds_read2st64_b64 v[16:19], v155 offset0:8 offset1:9
  v_smfmac_f32_32x32x32_bf16 v[40:55], v[28:31], v[80:87], v154
  v_exp_f32 v96, v96
  v_exp_f32 v97, v97
  v_exp_f32 v98, v98
  v_exp_f32 v99, v99
  v_smfmac_f32_32x32x32_bf16 v[56:71], v[24:27], v[88:95], v154
  v_exp_f32 v100, v100
  v_exp_f32 v101, v101
  v_exp_f32 v102, v102
  v_exp_f32 v103, v103
  s_setprio 0
  s_waitcnt lgkmcnt(0)
  v_exp_f32 v104, v104
  v_smfmac_f32_32x32x32_bf16 v[56:71], v[28:31], v[96:103], v154
  v_exp_f32 v105, v105
  v_exp_f32 v106, v106
  v_exp_f32 v107, v107
  v_mfma_f32_32x32x4_2b_bf16 v[72:103], v[20:21], v[152:153], 0
  v_exp_f32 v108, v108
  v_exp_f32 v109, v109
  v_exp_f32 v110, v110
  v_exp_f32 v111, v111
  v_exp_f32 v112, v112
  v_exp_f32 v113, v113
  v_exp_f32 v114, v114
  v_exp_f32 v115, v115
  s_mov_b64 exec, s[28:29]
  ds_read_b128 v[24:27], v157 offset:4608
  ds_read_b128 v[28:31], v22 offset:4608
  s_mov_b64 exec, -1
  v_smfmac_f32_32x32x32_bf16 v[40:55], v[32:35], v[104:111], v154
  v_exp_f32 v116, v116
  v_exp_f32 v117, v117
  v_exp_f32 v118, v118
  v_exp_f32 v119, v119
  ds_read_b32 v20, v156 offset:1280
  v_mfma_f32_32x32x16_bf16 v[72:87], v[16:19], v[144:147], v[72:87]
  v_exp_f32 v120, v120
  v_exp_f32 v121, v121
  v_exp_f32 v122, v122
  v_exp_f32 v123, v123
  v_mfma_f32_32x32x16_bf16 v[88:103], v[16:19], v[148:151], v[88:103]
  v_exp_f32 v124, v124
  v_exp_f32 v125, v125
  v_exp_f32 v126, v126
  v_exp_f32 v127, v127
  ds_read2st64_b64 v[16:19], v155 offset0:10 offset1:11
  v_smfmac_f32_32x32x32_bf16 v[40:55], v[36:39], v[112:119], v154
  v_exp_f32 v128, v128
  v_exp_f32 v129, v129
  v_exp_f32 v130, v130
  v_exp_f32 v131, v131
  v_smfmac_f32_32x32x32_bf16 v[56:71], v[32:35], v[120:127], v154
  v_exp_f32 v132, v132
  v_exp_f32 v133, v133
  v_exp_f32 v134, v134
  v_exp_f32 v135, v135
  s_setprio 3
  s_waitcnt lgkmcnt(0)
  v_exp_f32 v72, v72
  v_smfmac_f32_32x32x32_bf16 v[56:71], v[36:39], v[128:135], v154
  v_exp_f32 v73, v73
  v_exp_f32 v74, v74
  v_exp_f32 v75, v75
  v_mfma_f32_32x32x4_2b_bf16 v[104:135], v[20:21], v[152:153], 0
  v_exp_f32 v76, v76
  v_exp_f32 v77, v77
  v_exp_f32 v78, v78
  v_exp_f32 v79, v79
  v_exp_f32 v80, v80
  v_exp_f32 v81, v81
  v_exp_f32 v82, v82
  v_exp_f32 v83, v83
  s_mov_b64 exec, s[28:29]
  ds_read_b128 v[32:35], v157 offset:5760
  ds_read_b128 v[36:39], v22 offset:5760
  s_mov_b64 exec, -1
  v_smfmac_f32_32x32x32_bf16 v[40:55], v[24:27], v[72:79], v154
  v_exp_f32 v84, v84
  v_exp_f32 v85, v85
  v_exp_f32 v86, v86
  v_exp_f32 v87, v87
  ds_read_b32 v20, v156 offset:1536
  v_mfma_f32_32x32x16_bf16 v[104:119], v[16:19], v[144:147], v[104:119]
  v_exp_f32 v88, v88
  v_exp_f32 v89, v89
  v_exp_f32 v90, v90
  v_exp_f32 v91, v91
  v_mfma_f32_32x32x16_bf16 v[120:135], v[16:19], v[148:151], v[120:135]
  v_exp_f32 v92, v92
  v_exp_f32 v93, v93
  v_exp_f32 v94, v94
  v_exp_f32 v95, v95
  ds_read2st64_b64 v[16:19], v155 offset0:12 offset1:13
  v_smfmac_f32_32x32x32_bf16 v[40:55], v[28:31], v[80:87], v154
  v_exp_f32 v96, v96
  v_exp_f32 v97, v97
  v_exp_f32 v98, v98
  v_exp_f32 v99, v99
  v_smfmac_f32_32x32x32_bf16 v[56:71], v[24:27], v[88:95], v154
  v_exp_f32 v100, v100
  v_exp_f32 v101, v101
  v_exp_f32 v102, v102
  v_exp_f32 v103, v103
  s_setprio 2
  s_waitcnt lgkmcnt(0)
  v_exp_f32 v104, v104
  v_smfmac_f32_32x32x32_bf16 v[56:71], v[28:31], v[96:103], v154
  v_exp_f32 v105, v105
  v_exp_f32 v106, v106
  v_exp_f32 v107, v107
  v_mfma_f32_32x32x4_2b_bf16 v[72:103], v[20:21], v[152:153], 0
  v_exp_f32 v108, v108
  v_exp_f32 v109, v109
  v_exp_f32 v110, v110
  v_exp_f32 v111, v111
  v_exp_f32 v112, v112
  v_exp_f32 v113, v113
  v_exp_f32 v114, v114
  v_exp_f32 v115, v115
  s_mov_b64 exec, s[28:29]
  ds_read_b128 v[24:27], v157 offset:6912
  ds_read_b128 v[28:31], v22 offset:6912
  s_mov_b64 exec, -1
  v_smfmac_f32_32x32x32_bf16 v[40:55], v[32:35], v[104:111], v154
  v_exp_f32 v116, v116
  v_exp_f32 v117, v117
  v_exp_f32 v118, v118
  v_exp_f32 v119, v119
  ds_read_b32 v20, v156 offset:1792
  v_mfma_f32_32x32x16_bf16 v[72:87], v[16:19], v[144:147], v[72:87]
  v_exp_f32 v120, v120
  v_exp_f32 v121, v121
  v_exp_f32 v122, v122
  v_exp_f32 v123, v123
  v_mfma_f32_32x32x16_bf16 v[88:103], v[16:19], v[148:151], v[88:103]
  v_exp_f32 v124, v124
  v_exp_f32 v125, v125
  v_exp_f32 v126, v126
  v_exp_f32 v127, v127
  ds_read2st64_b64 v[16:19], v155 offset0:14 offset1:15
  v_smfmac_f32_32x32x32_bf16 v[40:55], v[36:39], v[112:119], v154
  v_exp_f32 v128, v128
  v_exp_f32 v129, v129
  v_exp_f32 v130, v130
  v_exp_f32 v131, v131
  v_smfmac_f32_32x32x32_bf16 v[56:71], v[32:35], v[120:127], v154
  v_exp_f32 v132, v132
  v_exp_f32 v133, v133
  v_exp_f32 v134, v134
  v_exp_f32 v135, v135
  s_setprio 1
  s_waitcnt lgkmcnt(0)
  v_exp_f32 v72, v72
  v_smfmac_f32_32x32x32_bf16 v[56:71], v[36:39], v[128:135], v154
  v_exp_f32 v73, v73
  v_exp_f32 v74, v74
  v_exp_f32 v75, v75
  v_mfma_f32_32x32x4_2b_bf16 v[104:135], v[20:21], v[152:153], 0
  v_exp_f32 v76, v76
  v_exp_f32 v77, v77
  v_exp_f32 v78, v78
  v_exp_f32 v79, v79
  v_exp_f32 v80, v80
  v_exp_f32 v81, v81
  v_exp_f32 v82, v82
  v_exp_f32 v83, v83
  ds_read_b32 v142, v143 offset:32
  s_mov_b64 exec, s[28:29]
  ds_read_b128 v[32:35], v157 offset:8064
  ds_read_b128 v[36:39], v22 offset:8064
  s_mov_b64 exec, -1
  v_smfmac_f32_32x32x32_bf16 v[40:55], v[24:27], v[72:79], v154
  v_exp_f32 v84, v84
  v_exp_f32 v85, v85
  v_exp_f32 v86, v86
  v_exp_f32 v87, v87
  s_nop 0
  v_mfma_f32_32x32x16_bf16 v[104:119], v[16:19], v[144:147], v[104:119]
  v_exp_f32 v88, v88
  v_exp_f32 v89, v89
  v_exp_f32 v90, v90
  v_exp_f32 v91, v91
  v_mfma_f32_32x32x16_bf16 v[120:135], v[16:19], v[148:151], v[120:135]
  v_exp_f32 v92, v92
  v_exp_f32 v93, v93
  v_exp_f32 v94, v94
  v_exp_f32 v95, v95
  s_waitcnt lgkmcnt(0)
  v_cmp_ne_u32 vcc, 0, v142
  s_mov_b64 exec, 1
  ds_write_b32 v23, v21 offset:96
  s_mov_b64 exec, -1
  s_cbranch_vccnz concat_heads__linear_kernel_hedgehog__softmax_full_mha__prompt_kernel_qs3
concat_heads__linear_kernel_hedgehog__softmax_full_mha__prompt_kernel_qr3:
  ds_read2st64_b64 v[16:19], v155 offset0:76 offset1:77
  ds_read_b32 v20, v156 offset:38912
  v_smfmac_f32_32x32x32_bf16 v[40:55], v[28:31], v[80:87], v154
  v_exp_f32 v96, v96
  v_exp_f32 v97, v97
  v_exp_f32 v98, v98
  v_exp_f32 v99, v99
  v_smfmac_f32_32x32x32_bf16 v[56:71], v[24:27], v[88:95], v154
  v_exp_f32 v100, v100
  v_exp_f32 v101, v101
  v_exp_f32 v102, v102
  v_exp_f32 v103, v103
  s_setprio 0
  s_waitcnt lgkmcnt(0)
  v_exp_f32 v104, v104
  v_smfmac_f32_32x32x32_bf16 v[56:71], v[28:31], v[96:103], v154
  v_exp_f32 v105, v105
  v_exp_f32 v106, v106
  v_exp_f32 v107, v107
  v_mfma_f32_32x32x4_2b_bf16 v[72:103], v[20:21], v[152:153], 0
  v_exp_f32 v108, v108
  v_exp_f32 v109, v109
  v_exp_f32 v110, v110
  v_exp_f32 v111, v111
  v_exp_f32 v112, v112
  v_exp_f32 v113, v113
  v_exp_f32 v114, v114
  v_exp_f32 v115, v115
  s_mov_b64 exec, s[28:29]
  ds_read_b128 v[24:27], v157 offset:38912
  ds_read_b128 v[28:31], v22 offset:38912
  s_mov_b64 exec, -1
  v_smfmac_f32_32x32x32_bf16 v[40:55], v[32:35], v[104:111], v154
  v_exp_f32 v116, v116
  v_exp_f32 v117, v117
  v_exp_f32 v118, v118
  v_exp_f32 v119, v119
  ds_read_b32 v20, v156 offset:39168
  v_mfma_f32_32x32x16_bf16 v[72:87], v[16:19], v[144:147], v[72:87]
  v_exp_f32 v120, v120
  v_exp_f32 v121, v121
  v_exp_f32 v122, v122
  v_exp_f32 v123, v123
  v_mfma_f32_32x32x16_bf16 v[88:103], v[16:19], v[148:151], v[88:103]
  v_exp_f32 v124, v124
  v_exp_f32 v125, v125
  v_exp_f32 v126, v126
  v_exp_f32 v127, v127
  ds_read2st64_b64 v[16:19], v155 offset0:78 offset1:79
  v_smfmac_f32_32x32x32_bf16 v[40:55], v[36:39], v[112:119], v154
  v_exp_f32 v128, v128
  v_exp_f32 v129, v129
  v_exp_f32 v130, v130
  v_exp_f32 v131, v131
  v_smfmac_f32_32x32x32_bf16 v[56:71], v[32:35], v[120:127], v154
  v_exp_f32 v132, v132
  v_exp_f32 v133, v133
  v_exp_f32 v134, v134
  v_exp_f32 v135, v135
  s_setprio 3
  s_waitcnt lgkmcnt(0)
  v_exp_f32 v72, v72
  v_smfmac_f32_32x32x32_bf16 v[56:71], v[36:39], v[128:135], v154
  v_exp_f32 v73, v73
  v_exp_f32 v74, v74
  v_exp_f32 v75, v75
  v_mfma_f32_32x32x4_2b_bf16 v[104:135], v[20:21], v[152:153], 0
  v_exp_f32 v76, v76
  v_exp_f32 v77, v77
  v_exp_f32 v78, v78
  v_exp_f32 v79, v79
  v_exp_f32 v80, v80
  v_exp_f32 v81, v81
  v_exp_f32 v82, v82
  v_exp_f32 v83, v83
  s_mov_b64 exec, s[28:29]
  ds_read_b128 v[32:35], v157 offset:40064
  ds_read_b128 v[36:39], v22 offset:40064
  s_mov_b64 exec, -1
  v_smfmac_f32_32x32x32_bf16 v[40:55], v[24:27], v[72:79], v154
  v_exp_f32 v84, v84
  v_exp_f32 v85, v85
  v_exp_f32 v86, v86
  v_exp_f32 v87, v87
  ds_read_b32 v20, v156 offset:39424
  v_mfma_f32_32x32x16_bf16 v[104:119], v[16:19], v[144:147], v[104:119]
  v_exp_f32 v88, v88
  v_exp_f32 v89, v89
  v_exp_f32 v90, v90
  v_exp_f32 v91, v91
  v_mfma_f32_32x32x16_bf16 v[120:135], v[16:19], v[148:151], v[120:135]
  v_exp_f32 v92, v92
  v_exp_f32 v93, v93
  v_exp_f32 v94, v94
  v_exp_f32 v95, v95
  ds_read2st64_b64 v[16:19], v155 offset0:80 offset1:81
  v_smfmac_f32_32x32x32_bf16 v[40:55], v[28:31], v[80:87], v154
  v_exp_f32 v96, v96
  v_exp_f32 v97, v97
  v_exp_f32 v98, v98
  v_exp_f32 v99, v99
  v_smfmac_f32_32x32x32_bf16 v[56:71], v[24:27], v[88:95], v154
  v_exp_f32 v100, v100
  v_exp_f32 v101, v101
  v_exp_f32 v102, v102
  v_exp_f32 v103, v103
  s_setprio 2
  s_waitcnt lgkmcnt(0)
  v_exp_f32 v104, v104
  v_smfmac_f32_32x32x32_bf16 v[56:71], v[28:31], v[96:103], v154
  v_exp_f32 v105, v105
  v_exp_f32 v106, v106
  v_exp_f32 v107, v107
  v_mfma_f32_32x32x4_2b_bf16 v[72:103], v[20:21], v[152:153], 0
  v_exp_f32 v108, v108
  v_exp_f32 v109, v109
  v_exp_f32 v110, v110
  v_exp_f32 v111, v111
  v_exp_f32 v112, v112
  v_exp_f32 v113, v113
  v_exp_f32 v114, v114
  v_exp_f32 v115, v115
  s_mov_b64 exec, s[28:29]
  ds_read_b128 v[24:27], v157 offset:41216
  ds_read_b128 v[28:31], v22 offset:41216
  s_mov_b64 exec, -1
  v_smfmac_f32_32x32x32_bf16 v[40:55], v[32:35], v[104:111], v154
  v_exp_f32 v116, v116
  v_exp_f32 v117, v117
  v_exp_f32 v118, v118
  v_exp_f32 v119, v119
  ds_read_b32 v20, v156 offset:39680
  v_mfma_f32_32x32x16_bf16 v[72:87], v[16:19], v[144:147], v[72:87]
  v_exp_f32 v120, v120
  v_exp_f32 v121, v121
  v_exp_f32 v122, v122
  v_exp_f32 v123, v123
  v_mfma_f32_32x32x16_bf16 v[88:103], v[16:19], v[148:151], v[88:103]
  v_exp_f32 v124, v124
  v_exp_f32 v125, v125
  v_exp_f32 v126, v126
  v_exp_f32 v127, v127
  ds_read2st64_b64 v[16:19], v155 offset0:82 offset1:83
  v_smfmac_f32_32x32x32_bf16 v[40:55], v[36:39], v[112:119], v154
  v_exp_f32 v128, v128
  v_exp_f32 v129, v129
  v_exp_f32 v130, v130
  v_exp_f32 v131, v131
  v_smfmac_f32_32x32x32_bf16 v[56:71], v[32:35], v[120:127], v154
  v_exp_f32 v132, v132
  v_exp_f32 v133, v133
  v_exp_f32 v134, v134
  v_exp_f32 v135, v135
  s_setprio 1
  s_waitcnt lgkmcnt(0)
  v_exp_f32 v72, v72
  v_smfmac_f32_32x32x32_bf16 v[56:71], v[36:39], v[128:135], v154
  v_exp_f32 v73, v73
  v_exp_f32 v74, v74
  v_exp_f32 v75, v75
  v_mfma_f32_32x32x4_2b_bf16 v[104:135], v[20:21], v[152:153], 0
  v_exp_f32 v76, v76
  v_exp_f32 v77, v77
  v_exp_f32 v78, v78
  v_exp_f32 v79, v79
  v_exp_f32 v80, v80
  v_exp_f32 v81, v81
  v_exp_f32 v82, v82
  v_exp_f32 v83, v83
  s_mov_b64 exec, s[28:29]
  ds_read_b128 v[32:35], v157 offset:42368
  ds_read_b128 v[36:39], v22 offset:42368
  s_mov_b64 exec, -1
  v_smfmac_f32_32x32x32_bf16 v[40:55], v[24:27], v[72:79], v154
  v_exp_f32 v84, v84
  v_exp_f32 v85, v85
  v_exp_f32 v86, v86
  v_exp_f32 v87, v87
  ds_read_b32 v20, v156 offset:39936
  v_mfma_f32_32x32x16_bf16 v[104:119], v[16:19], v[144:147], v[104:119]
  v_exp_f32 v88, v88
  v_exp_f32 v89, v89
  v_exp_f32 v90, v90
  v_exp_f32 v91, v91
  v_mfma_f32_32x32x16_bf16 v[120:135], v[16:19], v[148:151], v[120:135]
  v_exp_f32 v92, v92
  v_exp_f32 v93, v93
  v_exp_f32 v94, v94
  v_exp_f32 v95, v95
  ds_read2st64_b64 v[16:19], v155 offset0:84 offset1:85
  v_smfmac_f32_32x32x32_bf16 v[40:55], v[28:31], v[80:87], v154
  v_exp_f32 v96, v96
  v_exp_f32 v97, v97
  v_exp_f32 v98, v98
  v_exp_f32 v99, v99
  v_smfmac_f32_32x32x32_bf16 v[56:71], v[24:27], v[88:95], v154
  v_exp_f32 v100, v100
  v_exp_f32 v101, v101
  v_exp_f32 v102, v102
  v_exp_f32 v103, v103
  s_setprio 0
  s_waitcnt lgkmcnt(0)
  v_exp_f32 v104, v104
  v_smfmac_f32_32x32x32_bf16 v[56:71], v[28:31], v[96:103], v154
  v_exp_f32 v105, v105
  v_exp_f32 v106, v106
  v_exp_f32 v107, v107
  v_mfma_f32_32x32x4_2b_bf16 v[72:103], v[20:21], v[152:153], 0
  v_exp_f32 v108, v108
  v_exp_f32 v109, v109
  v_exp_f32 v110, v110
  v_exp_f32 v111, v111
  v_exp_f32 v112, v112
  v_exp_f32 v113, v113
  v_exp_f32 v114, v114
  v_exp_f32 v115, v115
  s_mov_b64 exec, s[28:29]
  ds_read_b128 v[24:27], v157 offset:43520
  ds_read_b128 v[28:31], v22 offset:43520
  s_mov_b64 exec, -1
  v_smfmac_f32_32x32x32_bf16 v[40:55], v[32:35], v[104:111], v154
  v_exp_f32 v116, v116
  v_exp_f32 v117, v117
  v_exp_f32 v118, v118
  v_exp_f32 v119, v119
  ds_read_b32 v20, v156 offset:40192
  v_mfma_f32_32x32x16_bf16 v[72:87], v[16:19], v[144:147], v[72:87]
  v_exp_f32 v120, v120
  v_exp_f32 v121, v121
  v_exp_f32 v122, v122
  v_exp_f32 v123, v123
  v_mfma_f32_32x32x16_bf16 v[88:103], v[16:19], v[148:151], v[88:103]
  v_exp_f32 v124, v124
  v_exp_f32 v125, v125
  v_exp_f32 v126, v126
  v_exp_f32 v127, v127
  ds_read2st64_b64 v[16:19], v155 offset0:86 offset1:87
  v_smfmac_f32_32x32x32_bf16 v[40:55], v[36:39], v[112:119], v154
  v_exp_f32 v128, v128
  v_exp_f32 v129, v129
  v_exp_f32 v130, v130
  v_exp_f32 v131, v131
  v_smfmac_f32_32x32x32_bf16 v[56:71], v[32:35], v[120:127], v154
  v_exp_f32 v132, v132
  v_exp_f32 v133, v133
  v_exp_f32 v134, v134
  v_exp_f32 v135, v135
  s_setprio 3
  s_waitcnt lgkmcnt(0)
  v_exp_f32 v72, v72
  v_smfmac_f32_32x32x32_bf16 v[56:71], v[36:39], v[128:135], v154
  v_exp_f32 v73, v73
  v_exp_f32 v74, v74
  v_exp_f32 v75, v75
  v_mfma_f32_32x32x4_2b_bf16 v[104:135], v[20:21], v[152:153], 0
  v_exp_f32 v76, v76
  v_exp_f32 v77, v77
  v_exp_f32 v78, v78
  v_exp_f32 v79, v79
  v_exp_f32 v80, v80
  v_exp_f32 v81, v81
  v_exp_f32 v82, v82
  v_exp_f32 v83, v83
  s_mov_b64 exec, s[28:29]
  ds_read_b128 v[32:35], v157 offset:44672
  ds_read_b128 v[36:39], v22 offset:44672
  s_mov_b64 exec, -1
  v_smfmac_f32_32x32x32_bf16 v[40:55], v[24:27], v[72:79], v154
  v_exp_f32 v84, v84
  v_exp_f32 v85, v85
  v_exp_f32 v86, v86
  v_exp_f32 v87, v87
  ds_read_b32 v20, v156 offset:40448
  v_mfma_f32_32x32x16_bf16 v[104:119], v[16:19], v[144:147], v[104:119]
  v_exp_f32 v88, v88
  v_exp_f32 v89, v89
  v_exp_f32 v90, v90
  v_exp_f32 v91, v91
  v_mfma_f32_32x32x16_bf16 v[120:135], v[16:19], v[148:151], v[120:135]
  v_exp_f32 v92, v92
  v_exp_f32 v93, v93
  v_exp_f32 v94, v94
  v_exp_f32 v95, v95
  ds_read2st64_b64 v[16:19], v155 offset0:88 offset1:89
  v_smfmac_f32_32x32x32_bf16 v[40:55], v[28:31], v[80:87], v154
  v_exp_f32 v96, v96
  v_exp_f32 v97, v97
  v_exp_f32 v98, v98
  v_exp_f32 v99, v99
  v_smfmac_f32_32x32x32_bf16 v[56:71], v[24:27], v[88:95], v154
  v_exp_f32 v100, v100
  v_exp_f32 v101, v101
  v_exp_f32 v102, v102
  v_exp_f32 v103, v103
  s_setprio 2
  s_waitcnt lgkmcnt(0)
  v_exp_f32 v104, v104
  v_smfmac_f32_32x32x32_bf16 v[56:71], v[28:31], v[96:103], v154
  v_exp_f32 v105, v105
  v_exp_f32 v106, v106
  v_exp_f32 v107, v107
  v_mfma_f32_32x32x4_2b_bf16 v[72:103], v[20:21], v[152:153], 0
  v_exp_f32 v108, v108
  v_exp_f32 v109, v109
  v_exp_f32 v110, v110
  v_exp_f32 v111, v111
  v_exp_f32 v112, v112
  v_exp_f32 v113, v113
  v_exp_f32 v114, v114
  v_exp_f32 v115, v115
  s_mov_b64 exec, s[28:29]
  ds_read_b128 v[24:27], v157 offset:45824
  ds_read_b128 v[28:31], v22 offset:45824
  s_mov_b64 exec, -1
  v_smfmac_f32_32x32x32_bf16 v[40:55], v[32:35], v[104:111], v154
  v_exp_f32 v116, v116
  v_exp_f32 v117, v117
  v_exp_f32 v118, v118
  v_exp_f32 v119, v119
  ds_read_b32 v20, v156 offset:40704
  v_mfma_f32_32x32x16_bf16 v[72:87], v[16:19], v[144:147], v[72:87]
  v_exp_f32 v120, v120
  v_exp_f32 v121, v121
  v_exp_f32 v122, v122
  v_exp_f32 v123, v123
  v_mfma_f32_32x32x16_bf16 v[88:103], v[16:19], v[148:151], v[88:103]
  v_exp_f32 v124, v124
  v_exp_f32 v125, v125
  v_exp_f32 v126, v126
  v_exp_f32 v127, v127
  ds_read2st64_b64 v[16:19], v155 offset0:90 offset1:91
  v_smfmac_f32_32x32x32_bf16 v[40:55], v[36:39], v[112:119], v154
  v_exp_f32 v128, v128
  v_exp_f32 v129, v129
  v_exp_f32 v130, v130
  v_exp_f32 v131, v131
  v_smfmac_f32_32x32x32_bf16 v[56:71], v[32:35], v[120:127], v154
  v_exp_f32 v132, v132
  v_exp_f32 v133, v133
  v_exp_f32 v134, v134
  v_exp_f32 v135, v135
  s_setprio 1
  s_waitcnt lgkmcnt(0)
  v_exp_f32 v72, v72
  v_smfmac_f32_32x32x32_bf16 v[56:71], v[36:39], v[128:135], v154
  v_exp_f32 v73, v73
  v_exp_f32 v74, v74
  v_exp_f32 v75, v75
  v_mfma_f32_32x32x4_2b_bf16 v[104:135], v[20:21], v[152:153], 0
  v_exp_f32 v76, v76
  v_exp_f32 v77, v77
  v_exp_f32 v78, v78
  v_exp_f32 v79, v79
  v_exp_f32 v80, v80
  v_exp_f32 v81, v81
  v_exp_f32 v82, v82
  v_exp_f32 v83, v83
  s_mov_b64 exec, s[28:29]
  ds_read_b128 v[32:35], v157 offset:46976
  ds_read_b128 v[36:39], v22 offset:46976
  s_mov_b64 exec, -1
  v_smfmac_f32_32x32x32_bf16 v[40:55], v[24:27], v[72:79], v154
  v_exp_f32 v84, v84
  v_exp_f32 v85, v85
  v_exp_f32 v86, v86
  v_exp_f32 v87, v87
  s_nop 0
  v_mfma_f32_32x32x16_bf16 v[104:119], v[16:19], v[144:147], v[104:119]
  v_exp_f32 v88, v88
  v_exp_f32 v89, v89
  v_exp_f32 v90, v90
  v_exp_f32 v91, v91
  v_mfma_f32_32x32x16_bf16 v[120:135], v[16:19], v[148:151], v[120:135]
  v_exp_f32 v92, v92
  v_exp_f32 v93, v93
  v_exp_f32 v94, v94
  v_exp_f32 v95, v95
  s_mov_b64 exec, 1
  ds_write_b32 v23, v21 offset:128
  s_mov_b64 exec, -1
  s_nop 0
  v_smfmac_f32_32x32x32_bf16 v[40:55], v[28:31], v[80:87], v154
  v_exp_f32 v96, v96
  v_exp_f32 v97, v97
  v_exp_f32 v98, v98
  v_exp_f32 v99, v99
  v_smfmac_f32_32x32x32_bf16 v[56:71], v[24:27], v[88:95], v154
  v_exp_f32 v100, v100
  v_exp_f32 v101, v101
  v_exp_f32 v102, v102
  v_exp_f32 v103, v103
  s_setprio 0
  s_waitcnt lgkmcnt(0)
  v_exp_f32 v104, v104
  v_smfmac_f32_32x32x32_bf16 v[56:71], v[28:31], v[96:103], v154
  v_exp_f32 v105, v105
  v_exp_f32 v106, v106
  v_exp_f32 v107, v107
  v_exp_f32 v108, v108
  v_exp_f32 v109, v109
  v_exp_f32 v110, v110
  v_exp_f32 v111, v111
  v_exp_f32 v112, v112
  v_exp_f32 v113, v113
  v_exp_f32 v114, v114
  v_exp_f32 v115, v115
  v_smfmac_f32_32x32x32_bf16 v[40:55], v[32:35], v[104:111], v154
  v_exp_f32 v116, v116
  v_exp_f32 v117, v117
  v_exp_f32 v118, v118
  v_exp_f32 v119, v119
  v_exp_f32 v120, v120
  v_exp_f32 v121, v121
  v_exp_f32 v122, v122
  v_exp_f32 v123, v123
  v_exp_f32 v124, v124
  v_exp_f32 v125, v125
  v_exp_f32 v126, v126
  v_exp_f32 v127, v127
  v_smfmac_f32_32x32x32_bf16 v[40:55], v[36:39], v[112:119], v154
  v_exp_f32 v128, v128
  v_exp_f32 v129, v129
  v_exp_f32 v130, v130
  v_exp_f32 v131, v131
  v_smfmac_f32_32x32x32_bf16 v[56:71], v[32:35], v[120:127], v154
  v_exp_f32 v132, v132
  v_exp_f32 v133, v133
  v_exp_f32 v134, v134
  v_exp_f32 v135, v135
  s_nop 1
  v_smfmac_f32_32x32x32_bf16 v[56:71], v[36:39], v[128:135], v154
  s_mov_b64 exec, 1
  ds_write_b32 v23, v21 offset:160
  s_mov_b64 exec, -1
  s_setprio 3
  s_and_b32 s56, s24, 3
  s_lshr_b32 s57, s56, 1
  s_mul_i32 s57, s57, 19456
  s_and_b32 s58, s56, 1
  s_lshl_b32 s58, s58, 13
  s_add_u32 s57, s57, s58
  s_add_u32 s57, s57, 38912
  v_add_u32 v4, s57, v1
  s_lshl_b32 s56, s56, 2
  s_add_u32 s56, s56, 161472
  v_mov_b32 v5, s56
  s_cmp_ge_u32 s24, 8
  s_cbranch_scc1 concat_heads__linear_kernel_hedgehog__softmax_full_mha__prompt_kernel_fx
  v_and_b32 v2, 7, v0
  v_lshlrev_b32 v2, 2, v2
  v_add_u32 v2, 161616, v2
  s_mov_b32 s61, 1048576
concat_heads__linear_kernel_hedgehog__softmax_full_mha__prompt_kernel_gb_39:
  ds_read_b32 v3, v2
  s_sub_u32 s61, s61, 1
  s_waitcnt lgkmcnt(0)
  s_cbranch_scc1 concat_heads__linear_kernel_hedgehog__softmax_full_mha__prompt_kernel_gb_39x
  v_cmp_ne_u32 vcc, 0, v3
  s_cbranch_vccz concat_heads__linear_kernel_hedgehog__softmax_full_mha__prompt_kernel_gb_39x
  s_branch concat_heads__linear_kernel_hedgehog__softmax_full_mha__prompt_kernel_gb_39
concat_heads__linear_kernel_hedgehog__softmax_full_mha__prompt_kernel_gb_39x:
  ds_write_b128 v4, v[40:43] offset:0
  ds_write_b128 v4, v[44:47] offset:1024
  ds_write_b128 v4, v[48:51] offset:2048
  ds_write_b128 v4, v[56:59] offset:3072
  ds_write_b128 v4, v[60:63] offset:4096
  ds_write_b128 v4, v[64:67] offset:5120
  v_mov_b32 v2, 0
  ds_write_b32 v5, v2
  s_endpgm
concat_heads__linear_kernel_hedgehog__softmax_full_mha__prompt_kernel_qs1:
  v_and_b32 v2, 3, v0
  v_lshlrev_b32 v2, 2, v2
  v_add_u32 v2, 161424, v2
  s_mov_b32 s61, 1048576
concat_heads__linear_kernel_hedgehog__softmax_full_mha__prompt_kernel_gb_40:
  ds_read_b32 v3, v2
  s_sub_u32 s61, s61, 1
  s_waitcnt lgkmcnt(0)
  s_cbranch_scc1 concat_heads__linear_kernel_hedgehog__softmax_full_mha__prompt_kernel_gb_40x
  v_cmp_ne_u32 vcc, 0, v3
  s_cbranch_vccz concat_heads__linear_kernel_hedgehog__softmax_full_mha__prompt_kernel_gb_40x
  s_branch concat_heads__linear_kernel_hedgehog__softmax_full_mha__prompt_kernel_gb_40
concat_heads__linear_kernel_hedgehog__softmax_full_mha__prompt_kernel_gb_40x:
  s_branch concat_heads__linear_kernel_hedgehog__softmax_full_mha__prompt_kernel_qr1
concat_heads__linear_kernel_hedgehog__softmax_full_mha__prompt_kernel_qs2:
  v_and_b32 v2, 3, v0
  v_lshlrev_b32 v2, 2, v2
  v_add_u32 v2, 161440, v2
  s_mov_b32 s61, 1048576
concat_heads__linear_kernel_hedgehog__softmax_full_mha__prompt_kernel_gb_41:
  ds_read_b32 v3, v2
  s_sub_u32 s61, s61, 1
  s_waitcnt lgkmcnt(0)
  s_cbranch_scc1 concat_heads__linear_kernel_hedgehog__softmax_full_mha__prompt_kernel_gb_41x
  v_cmp_ne_u32 vcc, 0, v3
  s_cbranch_vccz concat_heads__linear_kernel_hedgehog__softmax_full_mha__prompt_kernel_gb_41x
  s_branch concat_heads__linear_kernel_hedgehog__softmax_full_mha__prompt_kernel_gb_41
concat_heads__linear_kernel_hedgehog__softmax_full_mha__prompt_kernel_gb_41x:
  s_branch concat_heads__linear_kernel_hedgehog__softmax_full_mha__prompt_kernel_qr2
concat_heads__linear_kernel_hedgehog__softmax_full_mha__prompt_kernel_qs3:
  v_and_b32 v2, 3, v0
  v_lshlrev_b32 v2, 2, v2
  v_add_u32 v2, 161456, v2
  s_mov_b32 s61, 1048576
concat_heads__linear_kernel_hedgehog__softmax_full_mha__prompt_kernel_gb_42:
  ds_read_b32 v3, v2
  s_sub_u32 s61, s61, 1
  s_waitcnt lgkmcnt(0)
  s_cbranch_scc1 concat_heads__linear_kernel_hedgehog__softmax_full_mha__prompt_kernel_gb_42x
  v_cmp_ne_u32 vcc, 0, v3
  s_cbranch_vccz concat_heads__linear_kernel_hedgehog__softmax_full_mha__prompt_kernel_gb_42x
  s_branch concat_heads__linear_kernel_hedgehog__softmax_full_mha__prompt_kernel_gb_42
concat_heads__linear_kernel_hedgehog__softmax_full_mha__prompt_kernel_gb_42x:
  s_branch concat_heads__linear_kernel_hedgehog__softmax_full_mha__prompt_kernel_qr3
concat_heads__linear_kernel_hedgehog__softmax_full_mha__prompt_kernel_fx:
  v_mov_b32 v2, v5
  v_lshlrev_b32 v11, 2, v0
  s_mov_b32 s61, 1048576
concat_heads__linear_kernel_hedgehog__softmax_full_mha__prompt_kernel_gb_43:
  ds_read_b32 v3, v2
  s_sub_u32 s61, s61, 1
  s_waitcnt lgkmcnt(0)
  s_cbranch_scc1 concat_heads__linear_kernel_hedgehog__softmax_full_mha__prompt_kernel_gb_43x
  v_cmp_ne_u32 vcc, 0, v3
  s_cbranch_vccz concat_heads__linear_kernel_hedgehog__softmax_full_mha__prompt_kernel_gb_43x
  s_branch concat_heads__linear_kernel_hedgehog__softmax_full_mha__prompt_kernel_gb_43
concat_heads__linear_kernel_hedgehog__softmax_full_mha__prompt_kernel_gb_43x:
  ds_read_b128 v[104:107], v4 offset:0
  ds_read_b128 v[108:111], v4 offset:1024
  ds_read_b128 v[112:115], v4 offset:2048
  ds_read_b128 v[116:119], v4 offset:3072
  ds_read_b128 v[120:123], v4 offset:4096
  ds_read_b128 v[124:127], v4 offset:5120
  s_mov_b32 s56, 394264576
  s_mov_b32 s57, 1904214016
  s_mov_b32 s58, 2122317824
  s_waitcnt lgkmcnt(0)
  v_add_f32 v40, v40, v104
  v_add_f32 v41, v41, v105
  v_add_f32 v42, v42, v106
  v_add_f32 v43, v43, v107
  v_add_f32 v44, v44, v108
  v_add_f32 v45, v45, v109
  v_add_f32 v46, v46, v110
  v_add_f32 v47, v47, v111
  v_add_f32 v48, v48, v112
  v_add_f32 v49, v49, v113
  v_add_f32 v50, v50, v114
  v_add_f32 v51, v51, v115
  v_add_f32 v56, v56, v116
  v_add_f32 v57, v57, v117
  v_add_f32 v58, v58, v118
  v_add_f32 v59, v59, v119
  v_add_f32 v60, v60, v120
  v_add_f32 v61, v61, v121
  v_add_f32 v62, v62, v122
  v_add_f32 v63, v63, v123
  v_add_f32 v64, v64, v124
  v_add_f32 v65, v65, v125
  v_add_f32 v66, v66, v126
  v_add_f32 v67, v67, v127
  v_mov_b32 v51, v50
  v_mov_b32 v67, v66
  v_add_f32 v3, abs(v40), abs(v56)
  v_add_f32 v3, v3, abs(v41)
  v_add_f32 v3, v3, abs(v57)
  v_add_f32 v3, v3, abs(v42)
  v_add_f32 v3, v3, abs(v58)
  v_add_f32 v3, v3, abs(v43)
  v_add_f32 v3, v3, abs(v59)
  v_add_f32 v3, v3, abs(v44)
  v_add_f32 v3, v3, abs(v60)
  v_add_f32 v3, v3, abs(v45)
  v_add_f32 v3, v3, abs(v61)
  v_add_f32 v3, v3, abs(v46)
  v_add_f32 v3, v3, abs(v62)
  v_add_f32 v3, v3, abs(v47)
  v_add_f32 v3, v3, abs(v63)
  v_add_f32 v3, v3, abs(v48)
  v_add_f32 v3, v3, abs(v64)
  v_add_f32 v3, v3, abs(v49)
  v_add_f32 v3, v3, abs(v65)
  v_permlane32_swap_b32 v50, v51
  v_permlane32_swap_b32 v66, v67
  v_cmp_ge_f32 s[94:95], s58, v3
  v_cmp_le_f32 vcc, s56, v50
  s_and_b64 s[94:95], s[94:95], vcc
  v_cmp_ge_f32 vcc, s57, v50
  s_and_b64 s[94:95], s[94:95], vcc
  v_cmp_le_f32 vcc, s56, v66
  s_and_b64 s[94:95], s[94:95], vcc
  v_cmp_ge_f32 vcc, s57, v66
  s_and_b64 s[94:95], s[94:95], vcc
  s_cmp_eq_u64 s[94:95], -1
  s_cbranch_scc0 concat_heads__linear_kernel_hedgehog__softmax_full_mha__prompt_kernel_slow
concat_heads__linear_kernel_hedgehog__softmax_full_mha__prompt_kernel_fin:
  v_rcp_f32 v50, v50
  s_nop 0
  v_mul_f32 v40, v40, v50
  v_mul_f32 v41, v41, v50
  v_mul_f32 v42, v42, v50
  v_mul_f32 v43, v43, v50
  v_mul_f32 v44, v44, v50
  v_mul_f32 v45, v45, v50
  v_mul_f32 v46, v46, v50
  v_mul_f32 v47, v47, v50
  v_mul_f32 v48, v48, v50
  v_mul_f32 v49, v49, v50
  v_rcp_f32 v66, v66
  s_nop 0
  v_mul_f32 v56, v56, v66
  v_mul_f32 v57, v57, v66
  v_mul_f32 v58, v58, v66
  v_mul_f32 v59, v59, v66
  v_mul_f32 v60, v60, v66
  v_mul_f32 v61, v61, v66
  v_mul_f32 v62, v62, v66
  v_mul_f32 v63, v63, v66
  v_mul_f32 v64, v64, v66
  v_mul_f32 v65, v65, v66
  v_cvt_pk_bf16_f32 v72, v40, v41
  v_cvt_pk_bf16_f32 v73, v42, v43
  v_cvt_pk_bf16_f32 v74, v44, v45
  v_cvt_pk_bf16_f32 v75, v46, v47
  v_cvt_pk_bf16_f32 v76, v48, v49
  s_lshl_b32 s56, s65, 5
  s_add_u32 s56, s56, s32
  s_lshl_b32 s57, s56, 10
  s_add_u32 s57, s57, 20971520
  buffer_store_dwordx4 v[72:75], v1, s[4:7], s57 offen sc1
  s_lshl_b32 s56, s56, 7
  s_add_u32 s56, s56, 23068672
  s_mov_b32 exec_hi, 0
  buffer_store_dword v76, v11, s[4:7], s56 offen sc1
  s_mov_b64 exec, -1
  v_cvt_pk_bf16_f32 v80, v56, v57
  v_cvt_pk_bf16_f32 v81, v58, v59
  v_cvt_pk_bf16_f32 v82, v60, v61
  v_cvt_pk_bf16_f32 v83, v62, v63
  v_cvt_pk_bf16_f32 v84, v64, v65
  s_lshl_b32 s56, s65, 5
  s_add_u32 s56, s56, s32
  s_lshl_b32 s57, s56, 10
  s_add_u32 s57, s57, 21004288
  buffer_store_dwordx4 v[80:83], v1, s[4:7], s57 offen sc1
  s_lshl_b32 s56, s56, 7
  s_add_u32 s56, s56, 23072768
  s_mov_b32 exec_hi, 0
  buffer_store_dword v84, v11, s[4:7], s56 offen sc1
  s_mov_b64 exec, -1
  s_mov_b64 exec, 1
  ds_write_b32 v23, v21 offset:176
  s_mov_b64 exec, -1
  s_lshl_b32 s56, s33, 2
  s_and_b32 s57, s24, 3
  s_add_u32 s56, s56, s57
  s_lshl_b32 s56, s56, 5
  s_add_u32 s56, s56, s32
  s_lshl_b32 s56, s56, 7
  s_add_u32 s56, s56, 27787264
  s_waitcnt vmcnt(0)
  v_mov_b32 v136, s25
  v_mov_b32 v137, s26
  v_mov_b32 v138, s25
  v_mov_b32 v139, s26
  s_mov_b64 exec, 0xff
  buffer_store_dwordx4 v[136:139], v1, s[4:7], s56 offen sc1
  s_mov_b64 exec, -1
  s_nop 0
  s_endpgm
concat_heads__linear_kernel_hedgehog__softmax_full_mha__prompt_kernel_slow:
  s_and_b32 s61, s32, 1
  s_lshl_b32 s61, s61, 2
  v_lshl_add_u32 v4, v9, 3, s61
  s_and_b32 s61, s32, 1
  s_lshl_b32 s61, s61, 5
  v_lshlrev_b32 v12, 6, v8
  v_lshl_add_u32 v12, v9, 4, v12
  v_add_u32 v12, s61, v12
  v_add_u32 v12, 1792, v12
  s_lshl_b32 s61, s61, 5
  v_lshlrev_b32 v13, 8, v8
  v_lshl_add_u32 v13, v9, 4, v13
  v_cmp_gt_u32 vcc, 16, v9
  v_add_u32 v13, s61, v13
  s_nop 0
  v_cndmask_b32 v12, v12, v13, vcc
  v_mov_b32 v13, 128
  v_cndmask_b32 v13, v13, 0, vcc
  v_cndmask_b32 v2, 0, 1, vcc
  v_lshl_add_u32 v13, v2, 9, v13
  v_add_u32 v13, v12, v13
  v_lshl_add_u32 v5, v8, 30, v4
  v_lshlrev_b32 v14, 3, v0
  buffer_load_dword v152, v4, s[4:7], s66 offen offset:0 sc1
  v_mov_b32 v7, 0xff800000
  v_mov_b32 v40, 0
  v_mov_b32 v41, 0
  v_mov_b32 v42, 0
  v_mov_b32 v43, 0
  v_mov_b32 v44, 0
  v_mov_b32 v45, 0
  v_mov_b32 v46, 0
  v_mov_b32 v47, 0
  v_mov_b32 v48, 0
  v_mov_b32 v49, 0
  v_mov_b32 v50, 0
  v_mov_b32 v51, 0
  v_mov_b32 v52, 0
  v_mov_b32 v53, 0
  v_mov_b32 v54, 0
  v_mov_b32 v55, 0
  s_mov_b32 s56, s62
  s_mov_b32 s57, s64
  s_mov_b32 s58, s63
  s_mov_b32 s59, 64
concat_heads__linear_kernel_hedgehog__softmax_full_mha__prompt_kernel_slow00:
  buffer_load_dwordx2 v[16:17], v14, s[4:7], s56 offen sc1
  buffer_load_dwordx2 v[18:19], v14, s[4:7], s56 offen offset:512 sc1
  buffer_load_dword v20, v5, s[4:7], s57 offen sc1
  s_add_u32 s56, s56, 1024
  s_add_u32 s57, s57, 256
  s_add_u32 s58, s58, 2304
  s_waitcnt vmcnt(0)
  v_mfma_f32_32x32x16_bf16 v[104:119], v[16:19], v[144:147], 0
  v_mfma_f32_32x32x8_bf16 v[104:119], v[20:21], v[152:153], v[104:119]
  s_nop 11
  v_max3_f32 v7, v7, v104, v105
  v_max3_f32 v7, v7, v106, v107
  v_max3_f32 v7, v7, v108, v109
  v_max3_f32 v7, v7, v110, v111
  v_max3_f32 v7, v7, v112, v113
  v_max3_f32 v7, v7, v114, v115
  v_max3_f32 v7, v7, v116, v117
  v_max3_f32 v7, v7, v118, v119
  s_sub_u32 s59, s59, 1
  s_cmp_lg_u32 s59, 0
  s_nop 7
  s_cbranch_scc1 concat_heads__linear_kernel_hedgehog__softmax_full_mha__prompt_kernel_slow00
  v_mov_b32 v6, v7
  s_nop 1
  v_permlane32_swap_b32 v7, v6
  v_max_f32 v7, v7, v6
  s_mov_b32 s56, s62
  s_mov_b32 s57, s64
  s_mov_b32 s58, s63
  s_mov_b32 s59, 64
concat_heads__linear_kernel_hedgehog__softmax_full_mha__prompt_kernel_slow01:
  buffer_load_dwordx2 v[16:17], v14, s[4:7], s56 offen sc1
  buffer_load_dwordx2 v[18:19], v14, s[4:7], s56 offen offset:512 sc1
  buffer_load_dword v20, v5, s[4:7], s57 offen sc1
  s_mov_b64 exec, s[28:29]
  buffer_load_dwordx4 v[24:27], v12, s[4:7], s58 offen sc1
  buffer_load_dwordx4 v[28:31], v13, s[4:7], s58 offen sc1
  s_mov_b64 exec, -1
  s_add_u32 s56, s56, 1024
  s_add_u32 s57, s57, 256
  s_add_u32 s58, s58, 2304
  s_waitcnt vmcnt(0)
  v_mfma_f32_32x32x16_bf16 v[104:119], v[16:19], v[144:147], 0
  v_mfma_f32_32x32x8_bf16 v[104:119], v[20:21], v[152:153], v[104:119]
  s_nop 11
  v_sub_f32 v104, v104, v7
  v_sub_f32 v105, v105, v7
  v_sub_f32 v106, v106, v7
  v_sub_f32 v107, v107, v7
  v_sub_f32 v108, v108, v7
  v_sub_f32 v109, v109, v7
  v_sub_f32 v110, v110, v7
  v_sub_f32 v111, v111, v7
  v_sub_f32 v112, v112, v7
  v_sub_f32 v113, v113, v7
  v_sub_f32 v114, v114, v7
  v_sub_f32 v115, v115, v7
  v_sub_f32 v116, v116, v7
  v_sub_f32 v117, v117, v7
  v_sub_f32 v118, v118, v7
  v_sub_f32 v119, v119, v7
  v_exp_f32 v104, v104
  v_exp_f32 v105, v105
  v_exp_f32 v106, v106
  v_exp_f32 v107, v107
  v_exp_f32 v108, v108
  v_exp_f32 v109, v109
  v_exp_f32 v110, v110
  v_exp_f32 v111, v111
  v_exp_f32 v112, v112
  v_exp_f32 v113, v113
  v_exp_f32 v114, v114
  v_exp_f32 v115, v115
  v_exp_f32 v116, v116
  v_exp_f32 v117, v117
  v_exp_f32 v118, v118
  v_exp_f32 v119, v119
  s_nop 1
  v_smfmac_f32_32x32x32_bf16 v[40:55], v[24:27], v[104:111], v154
  v_smfmac_f32_32x32x32_bf16 v[40:55], v[28:31], v[112:119], v154
  s_sub_u32 s59, s59, 1
  s_cmp_lg_u32 s59, 0
  s_nop 7
  s_cbranch_scc1 concat_heads__linear_kernel_hedgehog__softmax_full_mha__prompt_kernel_slow01
  s_nop 7
  v_mov_b32 v51, v50
  s_nop 1
  v_permlane32_swap_b32 v50, v51
  buffer_load_dword v152, v4, s[4:7], s66 offen offset:256 sc1
  v_mov_b32 v7, 0xff800000
  v_mov_b32 v56, 0
  v_mov_b32 v57, 0
  v_mov_b32 v58, 0
  v_mov_b32 v59, 0
  v_mov_b32 v60, 0
  v_mov_b32 v61, 0
  v_mov_b32 v62, 0
  v_mov_b32 v63, 0
  v_mov_b32 v64, 0
  v_mov_b32 v65, 0
  v_mov_b32 v66, 0
  v_mov_b32 v67, 0
  v_mov_b32 v68, 0
  v_mov_b32 v69, 0
  v_mov_b32 v70, 0
  v_mov_b32 v71, 0
  s_mov_b32 s56, s62
  s_mov_b32 s57, s64
  s_mov_b32 s58, s63
  s_mov_b32 s59, 64
concat_heads__linear_kernel_hedgehog__softmax_full_mha__prompt_kernel_slow10:
  buffer_load_dwordx2 v[16:17], v14, s[4:7], s56 offen sc1
  buffer_load_dwordx2 v[18:19], v14, s[4:7], s56 offen offset:512 sc1
  buffer_load_dword v20, v5, s[4:7], s57 offen sc1
  s_add_u32 s56, s56, 1024
  s_add_u32 s57, s57, 256
  s_add_u32 s58, s58, 2304
  s_waitcnt vmcnt(0)
  v_mfma_f32_32x32x16_bf16 v[104:119], v[16:19], v[148:151], 0
  v_mfma_f32_32x32x8_bf16 v[104:119], v[20:21], v[152:153], v[104:119]
  s_nop 11
  v_max3_f32 v7, v7, v104, v105
  v_max3_f32 v7, v7, v106, v107
  v_max3_f32 v7, v7, v108, v109
  v_max3_f32 v7, v7, v110, v111
  v_max3_f32 v7, v7, v112, v113
  v_max3_f32 v7, v7, v114, v115
  v_max3_f32 v7, v7, v116, v117
  v_max3_f32 v7, v7, v118, v119
  s_sub_u32 s59, s59, 1
  s_cmp_lg_u32 s59, 0
  s_nop 7
  s_cbranch_scc1 concat_heads__linear_kernel_hedgehog__softmax_full_mha__prompt_kernel_slow10
  v_mov_b32 v6, v7
  s_nop 1
  v_permlane32_swap_b32 v7, v6
  v_max_f32 v7, v7, v6
  s_mov_b32 s56, s62
  s_mov_b32 s57, s64
  s_mov_b32 s58, s63
  s_mov_b32 s59, 64
concat_heads__linear_kernel_hedgehog__softmax_full_mha__prompt_kernel_slow11:
  buffer_load_dwordx2 v[16:17], v14, s[4:7], s56 offen sc1
  buffer_load_dwordx2 v[18:19], v14, s[4:7], s56 offen offset:512 sc1
  buffer_load_dword v20, v5, s[4:7], s57 offen sc1
  s_mov_b64 exec, s[28:29]
  buffer_load_dwordx4 v[24:27], v12, s[4:7], s58 offen sc1
  buffer_load_dwordx4 v[28:31], v13, s[4:7], s58 offen sc1
  s_mov_b64 exec, -1
  s_add_u32 s56, s56, 1024
  s_add_u32 s57, s57, 256
  s_add_u32 s58, s58, 2304
  s_waitcnt vmcnt(0)
  v_mfma_f32_32x32x16_bf16 v[104:119], v[16:19], v[148:151], 0
  v_mfma_f32_32x32x8_bf16 v[104:119], v[20:21], v[152:153], v[104:119]
  s_nop 11
  v_sub_f32 v104, v104, v7
  v_sub_f32 v105, v105, v7
  v_sub_f32 v106, v106, v7
  v_sub_f32 v107, v107, v7
  v_sub_f32 v108, v108, v7
  v_sub_f32 v109, v109, v7
  v_sub_f32 v110, v110, v7
  v_sub_f32 v111, v111, v7
  v_sub_f32 v112, v112, v7
  v_sub_f32 v113, v113, v7
  v_sub_f32 v114, v114, v7
  v_sub_f32 v115, v115, v7
  v_sub_f32 v116, v116, v7
  v_sub_f32 v117, v117, v7
  v_sub_f32 v118, v118, v7
  v_sub_f32 v119, v119, v7
  v_exp_f32 v104, v104
  v_exp_f32 v105, v105
  v_exp_f32 v106, v106
  v_exp_f32 v107, v107
  v_exp_f32 v108, v108
  v_exp_f32 v109, v109
  v_exp_f32 v110, v110
  v_exp_f32 v111, v111
  v_exp_f32 v112, v112
  v_exp_f32 v113, v113
  v_exp_f32 v114, v114
  v_exp_f32 v115, v115
  v_exp_f32 v116, v116
  v_exp_f32 v117, v117
  v_exp_f32 v118, v118
  v_exp_f32 v119, v119
  s_nop 1
  v_smfmac_f32_32x32x32_bf16 v[56:71], v[24:27], v[104:111], v154
  v_smfmac_f32_32x32x32_bf16 v[56:71], v[28:31], v[112:119], v154
  s_sub_u32 s59, s59, 1
  s_cmp_lg_u32 s59, 0
  s_nop 7
  s_cbranch_scc1 concat_heads__linear_kernel_hedgehog__softmax_full_mha__prompt_kernel_slow11
  s_nop 7
  v_mov_b32 v67, v66
  s_nop 1
  v_permlane32_swap_b32 v66, v67
  s_branch concat_heads__linear_kernel_hedgehog__softmax_full_mha__prompt_kernel_fin
concat_heads__linear_kernel_hedgehog__softmax_full_mha__prompt_kernel_end:
  s_endpgm
.section .rodata,"a"
.p2align 6
.amdhsa_kernel concat_heads__linear_kernel_hedgehog__softmax_full_mha__prompt_kernel
  .amdhsa_next_free_vgpr 168
  .amdhsa_next_free_sgpr 102
  .amdhsa_accum_offset 168
  .amdhsa_group_segment_fixed_size 0
  .amdhsa_kernarg_size 80
  .amdhsa_user_sgpr_count 2
  .amdhsa_user_sgpr_kernarg_segment_ptr 1
  .amdhsa_system_sgpr_workgroup_id_x 1
  .amdhsa_float_denorm_mode_32 3
.end_amdhsa_kernel
```
